```python
import torch

def _softmax(x, axis=-1):
    return torch.softmax(x, dim=axis)

def _gelu(x):
    return torch.nn.functional.gelu(x, approximate='tanh')

def _silu(x):
    return torch.nn.functional.silu(x)

def _sigmoid(x):
    return torch.sigmoid(x)

def _layernorm(x, axis=-1, eps=1e-05):
    m = x.mean(dim=axis, keepdim=True)
    v = x.var(dim=axis, keepdim=True, unbiased=False)
    return (x - m) / torch.sqrt(v + eps)

def _scatter_add(tgt, idx, src, axis=0):
    return tgt.clone().index_add_(axis, idx, src)

def _segment_sum(src, seg, n):
    out = torch.zeros((n,) + src.shape[1:], dtype=src.dtype)
    return out.index_add_(0, seg, src)

def _pad(x, pw):
    flat = tuple((v for pair in reversed(pw) for v in pair))
    return torch.nn.functional.pad(x, flat)
kernel_name = 'adaLN_cond__compressed_kv_cla__dense_activation_relu__decode'

def setup_inputs():

    _w = lambda a: (lambda t: t.to(torch.bfloat16) if t.is_floating_point() else t)(torch.as_tensor(a))

    def _A_setup():
        B, H, Sq, Sk, D, M = (4, 32, 1, 4096, 128, 512)
        Dc = 4 * D
        return {'x': _w((lambda *s: torch.randn(*s, dtype=torch.bfloat16) * 0.05)(B, Sq, M)), 'c_kv': _w((lambda *s: torch.randn(*s, dtype=torch.bfloat16) * 1.6)(B, Sk, Dc)), 'w_q': _w((lambda *s: torch.randn(*s, dtype=torch.bfloat16) * 1.6)(M, H, D) * M ** (-0.5)), 'w_uk': _w((lambda *s: torch.randn(*s, dtype=torch.bfloat16) * 1.6)(Dc, H, D) * Dc ** (-0.5)), 'w_uv': _w((lambda *s: torch.randn(*s, dtype=torch.bfloat16) * 1.6)(Dc, H, D) * Dc ** (-0.5)), 'w_o': _w((lambda *s: torch.randn(*s, dtype=torch.bfloat16) * 1.6)(H, D, M) * (H * D) ** (-0.5))}
    _A_in = _A_setup()

    def _B_setup():
        B, S, D, Dff = (4, 1, 512, 1376)
        return {'x': _w((lambda *s: torch.randn(*s, dtype=torch.bfloat16) * 0.05)(B, S, D)), 'w1': _w((lambda *s: torch.randn(*s, dtype=torch.bfloat16) * 0.05)(D, Dff)), 'w2': _w((lambda *s: torch.randn(*s, dtype=torch.bfloat16) * 0.05)(Dff, D))}
    _B_in = _B_setup()
    return {'A_x': _A_in['x'], 'A_c_kv': _A_in['c_kv'], 'A_w_q': _A_in['w_q'], 'A_w_uk': _A_in['w_uk'], 'A_w_uv': _A_in['w_uv'], 'A_w_o': _A_in['w_o'], 'B_x': _B_in['x'], 'B_w1': _B_in['w1'], 'B_w2': _B_in['w2'], 'c': _w((lambda *s: torch.randn(*s, dtype=torch.bfloat16) * 0.2)(4, 512) * 8.0), 'w_mod': _w((lambda *s: torch.randn(*s, dtype=torch.bfloat16) * 0.2)(512, 6 * 512) * 512 ** (-0.5) * 8.0)}

def reference(A_x, A_c_kv, A_w_q, A_w_uk, A_w_uv, A_w_o, B_x, B_w1, B_w2, c, w_mod):

    def _A_ref(x, c_kv, w_q, w_uk, w_uv, w_o):
        B, Sq, M = (x.shape[0], x.shape[1], x.shape[2])
        Sk = c_kv.shape[1]
        H, D = (w_q.shape[1], w_q.shape[2])
        q = torch.einsum('bqm,mhd->bhqd', x, w_q)
        k = torch.einsum('bkc,chd->bhkd', c_kv, w_uk)
        v = torch.einsum('bkc,chd->bhkd', c_kv, w_uv)
        scores = torch.einsum('bhqd,bhkd->bhqk', q, k) * D ** (-0.5)
        off = Sk - Sq
        qi = torch.arange(Sq)[:, None]
        kj = torch.arange(Sk)[None, :]
        cmask = kj <= qi + off
        scores = torch.where(cmask[None, None], scores, -1000000000.0)
        p = _softmax(scores, axis=-1)
        ctx = torch.einsum('bhqk,bhkd->bhqd', p, v)
        return torch.einsum('bhqd,hdm->bqm', ctx, w_o)

    def _B_ref(x, w1, w2):
        h = torch.einsum('bsd,df->bsf', x, w1)
        zero = torch.zeros_like(h)
        h = torch.maximum(h, zero)
        return torch.einsum('bsf,fd->bsd', h, w2)
    x = A_x
    mod = (_silu(c) @ w_mod).reshape(c.shape[0], 6, 1, -1)
    sa, ca, ga, sb, cb, gb = (mod[:, 0].clone(), mod[:, 1].clone(), mod[:, 2].clone(), mod[:, 3].clone(), mod[:, 4].clone(), mod[:, 5].clone())
    h = _layernorm(x, axis=-1) * (1 + ca) + sa
    x = x + ga * _A_ref(h, A_c_kv, A_w_q, A_w_uk, A_w_uv, A_w_o)
    h = _layernorm(x, axis=-1) * (1 + cb) + sb
    x = x + gb * _B_ref(h, B_w1, B_w2)
    return x
```

```asm
; @launch grid=(256,1,1) block=(256,1,1) lds=163840
.amdgcn_target "amdgcn-amd-amdhsa--gfx950"
.text
.globl adaLN_cond__compressed_kv_cla__dense_activation_relu__decode_kernel
.p2align 8
.type adaLN_cond__compressed_kv_cla__dense_activation_relu__decode_kernel,@function
adaLN_cond__compressed_kv_cla__dense_activation_relu__decode_kernel:

    s_cmp_lt_u32 s2, 256
    s_cbranch_scc1 L_start
    s_endpgm
    L_start:

    s_load_dwordx2 s[8:9], s[0:1], 104

    s_and_b32 s3, s2, 7
    s_lshr_b32 s4, s2, 3
    v_lshrrev_b32 v2, 6, v0
    v_and_b32 v1, 63, v0
    v_mov_b32 v3, 0
    v_readfirstlane_b32 s6, v2

    s_mov_b32 s10, 6291456
    s_mov_b32 s11, 0x00020000
    s_cmp_lg_u32 s6, 3
    s_cbranch_scc1 L_nopf_1
    s_getpc_b64 s[16:17]
L_pcref:
    s_lshl_b32 s18, s4, 10
    v_and_b32 v2, 7, v1
    v_lshlrev_b32 v2, 7, v2
    v_add_u32 v2, s18, v2
    v_min_u32 v2, L_code_end-L_pcref-4, v2
    global_load_dword a255, v2, s[16:17]
L_nopf_1:
    s_lshr_b32 s12, s3, 1
    s_bitcmp1_b32 s3, 0
    s_cbranch_scc1 L_W
    s_load_dwordx2 s[40:41], s[0:1], 72
    s_load_dwordx2 s[44:45], s[0:1], 80
    s_load_dwordx2 s[64:65], s[0:1], 8
    s_load_dwordx2 s[48:49], s[0:1], 0
    s_load_dwordx2 s[52:53], s[0:1], 56
    s_load_dwordx2 s[56:57], s[0:1], 64
    s_load_dwordx2 s[60:61], s[0:1], 88
    s_mov_b32 s42, 4096
    s_mov_b32 s43, 0x00020000
    s_mov_b32 s46, 3145728
    s_mov_b32 s47, 0x00020000
    s_mov_b32 s66, 16777216
    s_mov_b32 s67, 0x00020000
    s_mov_b32 s50, 4096
    s_mov_b32 s51, 0x00020000
    s_mov_b32 s54, 1409024
    s_mov_b32 s55, 0x00020000
    s_mov_b32 s58, 1409024
    s_mov_b32 s59, 0x00020000
    s_mov_b32 s62, 4096
    s_mov_b32 s63, 0x00020000
    s_lshl_b32 s16, s12, 12
    s_lshl_b32 s18, s4, 7
    s_add_u32 s16, s16, s18
    s_lshl_b32 s17, s6, 5
    s_add_u32 s16, s16, s17
    s_lshl_b32 s18, s16, 10
    s_add_u32 s16, s4, 22
    s_cmp_eq_u32 s12, 0
    s_cselect_b32 s71, s4, s16
    s_cselect_b32 s17, 22, 21
    s_cmp_lt_u32 s4, s17
    s_cselect_b32 s71, s71, 63
    s_cmp_lt_u32 s12, 2
    s_cselect_b32 s71, s71, 63
    s_cmp_eq_u32 s6, 0
    s_cbranch_scc0 L_A_others
    s_lshl_b32 s13, s12, 4
    s_lshr_b32 s16, s4, 1
    s_add_u32 s13, s13, s16
    s_and_b32 s14, s4, 1
    v_lshrrev_b32 v140, 4, v1
    v_and_b32 v141, 15, v1
    v_lshlrev_b32 v125, 10, v140
    v_lshl_add_u32 v125, v141, 4, v125
    v_lshrrev_b32 v126, 1, v1
    v_mul_u32_u24 v126, 6144, v126
    v_and_b32 v127, 1, v1
    v_lshl_add_u32 v126, v127, 4, v126
    s_lshl_b32 s17, s14, 9
    s_mul_i32 s15, s14, 1572864
    s_lshl_b32 s16, s13, 5
    s_add_u32 s15, s15, s16
    s_mov_b32 m0, 131072
    s_waitcnt lgkmcnt(0)
    buffer_load_dword v4, v3, s[8:11], 0 offen sc1
    buffer_load_dwordx4 v[128:131], v125, s[40:43], s17 offen
    buffer_load_dwordx4 v[132:135], v125, s[40:43], s17 offen offset:256
    buffer_load_dwordx4 v126, s[44:47], s15 offen  lds
    s_add_u32 s15, s15, 196608
    s_add_u32 m0, m0, 1024
    s_nop 0
    buffer_load_dwordx4 v126, s[44:47], s15 offen  lds
    s_add_u32 s15, s15, 196608
    s_add_u32 m0, m0, 1024
    s_nop 0
    buffer_load_dwordx4 v126, s[44:47], s15 offen  lds
    s_add_u32 s15, s15, 196608
    s_add_u32 m0, m0, 1024
    s_nop 0
    buffer_load_dwordx4 v126, s[44:47], s15 offen  lds
    s_add_u32 s15, s15, 196608
    s_add_u32 m0, m0, 1024
    s_nop 0
    buffer_load_dwordx4 v126, s[44:47], s15 offen  lds
    s_add_u32 s15, s15, 196608
    s_add_u32 m0, m0, 1024
    s_nop 0
    buffer_load_dwordx4 v126, s[44:47], s15 offen  lds
    s_add_u32 s15, s15, 196608
    s_add_u32 m0, m0, 1024
    s_nop 0
    buffer_load_dwordx4 v126, s[44:47], s15 offen  lds
    s_add_u32 s15, s15, 196608
    s_add_u32 m0, m0, 1024
    s_nop 0
    buffer_load_dwordx4 v126, s[44:47], s15 offen  lds
    v_mul_u32_u24 v142, 576, v140
    v_lshl_add_u32 v142, v141, 4, v142
    v_add_u32 v142, 139264, v142
    v_and_b32 v143, 3, v1
    v_mul_u32_u24 v143, 576, v143
    v_lshl_add_u32 v143, v140, 4, v143
    v_add_u32 v143, 139264, v143
    v_bfe_u32 v144, v1, 2, 2
    v_lshl_add_u32 v144, v140, 3, v144
    v_lshlrev_b32 v144, 5, v144
    v_and_b32 v145, 3, v1
    v_lshl_add_u32 v144, v145, 3, v144
    v_add_u32 v144, 131072, v144
    v_lshlrev_b32 v145, 6, v145
    v_lshl_add_u32 v145, v140, 4, v145
    s_lshl_b32 s19, s13, 9
    s_lshl_b32 s16, s14, 8
    s_add_u32 s19, s19, s16
    s_add_u32 s19, s19, 65536
    s_waitcnt vmcnt(8)
    v_readfirstlane_b32 s5, v4
    s_mul_i32 s5, s5, 2654435761
    s_add_u32 s5, s5, 2135587861
    v_lshlrev_b32 v152, 16, v128
    v_and_b32 v153, 0xffff0000, v128
    v_lshlrev_b32 v154, 16, v129
    v_and_b32 v155, 0xffff0000, v129
    v_lshlrev_b32 v156, 16, v130
    v_and_b32 v157, 0xffff0000, v130
    v_lshlrev_b32 v158, 16, v131
    v_and_b32 v159, 0xffff0000, v131
    s_mov_b32 s16, 3216550459
    v_mul_f32 v160, s16, v152
    v_mul_f32 v161, s16, v153
    v_mul_f32 v162, s16, v154
    v_mul_f32 v163, s16, v155
    v_mul_f32 v164, s16, v156
    v_mul_f32 v165, s16, v157
    v_mul_f32 v166, s16, v158
    v_mul_f32 v167, s16, v159
    v_exp_f32 v160, v160
    v_exp_f32 v161, v161
    v_exp_f32 v162, v162
    v_exp_f32 v163, v163
    v_exp_f32 v164, v164
    v_exp_f32 v165, v165
    v_exp_f32 v166, v166
    v_exp_f32 v167, v167
    v_add_f32 v160, 1.0, v160
    v_add_f32 v161, 1.0, v161
    v_add_f32 v162, 1.0, v162
    v_add_f32 v163, 1.0, v163
    v_add_f32 v164, 1.0, v164
    v_add_f32 v165, 1.0, v165
    v_add_f32 v166, 1.0, v166
    v_add_f32 v167, 1.0, v167
    v_rcp_f32 v160, v160
    v_rcp_f32 v161, v161
    v_rcp_f32 v162, v162
    v_rcp_f32 v163, v163
    v_rcp_f32 v164, v164
    v_rcp_f32 v165, v165
    v_rcp_f32 v166, v166
    v_rcp_f32 v167, v167
    v_mul_f32 v152, v152, v160
    v_mul_f32 v153, v153, v161
    v_mul_f32 v154, v154, v162
    v_mul_f32 v155, v155, v163
    v_mul_f32 v156, v156, v164
    v_mul_f32 v157, v157, v165
    v_mul_f32 v158, v158, v166
    v_mul_f32 v159, v159, v167
    v_cvt_pk_bf16_f32 v128, v152, v153
    v_cvt_pk_bf16_f32 v129, v154, v155
    v_cvt_pk_bf16_f32 v130, v156, v157
    v_cvt_pk_bf16_f32 v131, v158, v159
    v_lshlrev_b32 v152, 16, v132
    v_and_b32 v153, 0xffff0000, v132
    v_lshlrev_b32 v154, 16, v133
    v_and_b32 v155, 0xffff0000, v133
    v_lshlrev_b32 v156, 16, v134
    v_and_b32 v157, 0xffff0000, v134
    v_lshlrev_b32 v158, 16, v135
    v_and_b32 v159, 0xffff0000, v135
    s_mov_b32 s16, 3216550459
    v_mul_f32 v160, s16, v152
    v_mul_f32 v161, s16, v153
    v_mul_f32 v162, s16, v154
    v_mul_f32 v163, s16, v155
    v_mul_f32 v164, s16, v156
    v_mul_f32 v165, s16, v157
    v_mul_f32 v166, s16, v158
    v_mul_f32 v167, s16, v159
    v_exp_f32 v160, v160
    v_exp_f32 v161, v161
    v_exp_f32 v162, v162
    v_exp_f32 v163, v163
    v_exp_f32 v164, v164
    v_exp_f32 v165, v165
    v_exp_f32 v166, v166
    v_exp_f32 v167, v167
    v_add_f32 v160, 1.0, v160
    v_add_f32 v161, 1.0, v161
    v_add_f32 v162, 1.0, v162
    v_add_f32 v163, 1.0, v163
    v_add_f32 v164, 1.0, v164
    v_add_f32 v165, 1.0, v165
    v_add_f32 v166, 1.0, v166
    v_add_f32 v167, 1.0, v167
    v_rcp_f32 v160, v160
    v_rcp_f32 v161, v161
    v_rcp_f32 v162, v162
    v_rcp_f32 v163, v163
    v_rcp_f32 v164, v164
    v_rcp_f32 v165, v165
    v_rcp_f32 v166, v166
    v_rcp_f32 v167, v167
    v_mul_f32 v152, v152, v160
    v_mul_f32 v153, v153, v161
    v_mul_f32 v154, v154, v162
    v_mul_f32 v155, v155, v163
    v_mul_f32 v156, v156, v164
    v_mul_f32 v157, v157, v165
    v_mul_f32 v158, v158, v166
    v_mul_f32 v159, v159, v167
    v_cvt_pk_bf16_f32 v132, v152, v153
    v_cvt_pk_bf16_f32 v133, v154, v155
    v_cvt_pk_bf16_f32 v134, v156, v157
    v_cvt_pk_bf16_f32 v135, v158, v159
    ds_write_b128 v142, v[128:131]
    ds_write_b128 v142, v[132:135] offset:256
    s_waitcnt lgkmcnt(0)
    ds_read_b128 v[152:155], v143 offset:0
    ds_read_b128 v[156:159], v143 offset:64
    ds_read_b128 v[160:163], v143 offset:128
    ds_read_b128 v[164:167], v143 offset:192
    ds_read_b128 v[168:171], v143 offset:256
    ds_read_b128 v[172:175], v143 offset:320
    ds_read_b128 v[176:179], v143 offset:384
    ds_read_b128 v[180:183], v143 offset:448
    v_mov_b32 v137, s5
    v_mov_b32 v139, s5
    s_mov_b32 s70, s19
    v_xor_b32 v8, 0, v1
    v_xor_b32 v9, 4, v1
    v_xor_b32 v10, 8, v1
    v_xor_b32 v11, 12, v1
    v_xor_b32 v12, 1, v1
    v_xor_b32 v13, 5, v1
    v_xor_b32 v14, 9, v1
    v_xor_b32 v15, 13, v1
    v_xor_b32 v16, 2, v1
    v_xor_b32 v17, 6, v1
    v_xor_b32 v18, 10, v1
    v_xor_b32 v19, 14, v1
    v_xor_b32 v20, 3, v1
    v_xor_b32 v21, 7, v1
    v_xor_b32 v22, 11, v1
    v_xor_b32 v23, 15, v1
    v_lshlrev_b32 v8, 4, v8
    v_lshlrev_b32 v9, 4, v9
    v_lshlrev_b32 v10, 4, v10
    v_lshlrev_b32 v11, 4, v11
    v_lshlrev_b32 v12, 4, v12
    v_lshlrev_b32 v13, 4, v13
    v_lshlrev_b32 v14, 4, v14
    v_lshlrev_b32 v15, 4, v15
    v_lshlrev_b32 v16, 4, v16
    v_lshlrev_b32 v17, 4, v17
    v_lshlrev_b32 v18, 4, v18
    v_lshlrev_b32 v19, 4, v19
    v_lshlrev_b32 v20, 4, v20
    v_lshlrev_b32 v21, 4, v21
    v_lshlrev_b32 v22, 4, v22
    v_lshlrev_b32 v23, 4, v23
    s_add_u32 s16, s6, 0
    v_xor_b32 v24, s16, v1
    v_lshlrev_b32 v24, 4, v24
    s_lshl_b32 s16, s16, 10
    s_add_u32 s16, s16, 131072
    v_add_u32 v24, s16, v24
    s_add_u32 s16, s6, 4
    v_xor_b32 v25, s16, v1
    v_lshlrev_b32 v25, 4, v25
    s_lshl_b32 s16, s16, 10
    s_add_u32 s16, s16, 131072
    v_add_u32 v25, s16, v25
    s_add_u32 s16, s6, 8
    v_xor_b32 v26, s16, v1
    v_lshlrev_b32 v26, 4, v26
    s_lshl_b32 s16, s16, 10
    s_add_u32 s16, s16, 131072
    v_add_u32 v26, s16, v26
    s_add_u32 s16, s6, 12
    v_xor_b32 v27, s16, v1
    v_lshlrev_b32 v27, 4, v27
    s_lshl_b32 s16, s16, 10
    s_add_u32 s16, s16, 131072
    v_add_u32 v27, s16, v27
    v_and_b32 v36, 15, v1
    v_lshrrev_b32 v37, 5, v1
    v_xor_b32 v36, v36, v37
    v_lshlrev_b32 v36, 4, v36
    v_and_b32 v37, 31, v1
    v_lshlrev_b32 v37, 10, v37
    v_add_u32 v37, 131072, v37
    v_add_u32 v36, v36, v37
    v_xor_b32 v28, 0, v36
    v_xor_b32 v29, 32, v36
    v_xor_b32 v30, 64, v36
    v_xor_b32 v31, 96, v36
    v_xor_b32 v32, 128, v36
    v_xor_b32 v33, 160, v36
    v_xor_b32 v34, 192, v36
    v_xor_b32 v35, 224, v36
    v_and_b32 v44, 3, v1
    v_lshlrev_b32 v44, 2, v44
    v_bfe_u32 v45, v1, 2, 2
    v_or_b32 v44, v44, v45
    v_lshrrev_b32 v45, 5, v1
    v_xor_b32 v44, v44, v45
    v_lshlrev_b32 v44, 4, v44
    v_and_b32 v45, 31, v1
    v_lshlrev_b32 v45, 10, v45
    s_lshl_b32 s16, s6, 15
    s_add_u32 s16, s16, 0
    v_add_u32 v45, s16, v45
    v_add_u32 v44, v44, v45
    v_xor_b32 v36, 0, v44
    v_xor_b32 v37, 32, v44
    v_xor_b32 v38, 64, v44
    v_xor_b32 v39, 96, v44
    v_xor_b32 v40, 128, v44
    v_xor_b32 v41, 160, v44
    v_xor_b32 v42, 192, v44
    v_xor_b32 v43, 224, v44
    v_lshrrev_b32 v44, 5, v1
    v_bfe_u32 v45, v1, 2, 2
    v_bfe_u32 v46, v1, 4, 1
    v_bfe_u32 v47, v1, 1, 1
    v_lshl_or_b32 v46, v46, 1, v47
    v_xor_b32 v46, v46, v44
    v_lshl_or_b32 v46, v45, 2, v46
    v_lshlrev_b32 v46, 4, v46
    v_lshl_add_u32 v44, v44, 2, v45
    v_lshlrev_b32 v44, 10, v44
    v_and_b32 v45, 1, v1
    v_lshl_add_u32 v44, v45, 3, v44
    s_lshl_b32 s16, s6, 8
    s_add_u32 s16, s16, 0
    v_add_u32 v44, s16, v44
    v_add_u32 v44, v44, v46
    v_xor_b32 v232, 0, v44
    v_add_u32 v240, 0x10000, v232
    v_xor_b32 v233, 32, v44
    v_add_u32 v241, 0x10000, v233
    v_xor_b32 v234, 64, v44
    v_add_u32 v242, 0x10000, v234
    v_xor_b32 v235, 96, v44
    v_add_u32 v243, 0x10000, v235
    v_xor_b32 v236, 128, v44
    v_add_u32 v244, 0x10000, v236
    v_xor_b32 v237, 160, v44
    v_add_u32 v245, 0x10000, v237
    v_xor_b32 v238, 192, v44
    v_add_u32 v246, 0x10000, v238
    v_xor_b32 v239, 224, v44
    v_add_u32 v247, 0x10000, v239
    s_lshl_b32 s16, s12, 15
    s_lshl_b32 s17, s6, 10
    s_add_u32 s16, s16, s17
    s_add_u32 s24, s16, 393216
    s_add_u32 s25, s24, 4096
    s_add_u32 s26, s25, 4096
    s_add_u32 s27, s26, 4096
    s_add_u32 s28, s27, 4096
    s_add_u32 s29, s28, 4096
    s_add_u32 s30, s29, 4096
    s_add_u32 s31, s30, 4096
    v_lshlrev_b32 v48, 4, v1
    v_lshrrev_b32 v49, 5, v1
    s_mov_b32 s16, 593920
    v_mul_lo_u32 v49, v49, s16
    v_and_b32 v50, 31, v1
    v_lshl_add_u32 v49, v50, 2, v49
    v_lshlrev_b32 v50, 4, v50
    v_add_u32 v51, 131072, v50
    s_lshl_b32 s16, s6, 2
    v_add_u32 v50, s16, v51
    v_add_u32 v53, 132096, v48
    s_lshl_b32 s16, s6, 11
    v_add_u32 v52, s16, v53
    s_mul_i32 s20, s6, 37120
    s_lshl_b32 s16, s12, 13
    s_add_u32 s20, s20, s16
    s_lshl_b32 s16, s4, 8
    s_add_u32 s20, s20, s16
    s_add_u32 s20, s20, 1048576
    s_lshl_b32 s21, s12, 5
    s_add_u32 s21, s21, s4
    s_lshl_b32 s21, s21, 9
    s_add_u32 s21, s21, 524288
    s_lshl_b32 s22, s6, 2
    s_add_u32 s22, s22, s12
    s_lshl_b32 s22, s22, 5
    s_add_u32 s22, s22, s4
    s_lshl_b32 s22, s22, 7
    s_add_u32 s22, s22, 983040
    v_bfe_u32 v54, v1, 2, 3
    v_and_b32 v55, 1, v54
    v_lshlrev_b32 v55, 2, v55
    v_add_u32 v55, s6, v55
    v_and_b32 v56, 3, v1
    v_lshl_add_u32 v55, v55, 2, v56
    v_lshlrev_b32 v55, 3, v55
    v_and_b32 v54, 6, v54
    v_add3_u32 v55, v55, v54, 1
    v_lshlrev_b32 v55, 7, v55
    s_waitcnt vmcnt(0) lgkmcnt(0)
    ds_read_b64_tr_b16 v[184:185], v144 offset:0
    ds_read_b64_tr_b16 v[186:187], v144 offset:128
    ds_read_b64_tr_b16 v[188:189], v144 offset:1024
    ds_read_b64_tr_b16 v[190:191], v144 offset:1152
    ds_read_b64_tr_b16 v[192:193], v144 offset:2048
    ds_read_b64_tr_b16 v[194:195], v144 offset:2176
    ds_read_b64_tr_b16 v[196:197], v144 offset:3072
    ds_read_b64_tr_b16 v[198:199], v144 offset:3200
    ds_read_b64_tr_b16 v[200:201], v144 offset:4096
    ds_read_b64_tr_b16 v[202:203], v144 offset:4224
    ds_read_b64_tr_b16 v[204:205], v144 offset:5120
    ds_read_b64_tr_b16 v[206:207], v144 offset:5248
    ds_read_b64_tr_b16 v[208:209], v144 offset:6144
    ds_read_b64_tr_b16 v[210:211], v144 offset:6272
    ds_read_b64_tr_b16 v[212:213], v144 offset:7168
    ds_read_b64_tr_b16 v[214:215], v144 offset:7296
    s_waitcnt lgkmcnt(14)
    v_mfma_f32_16x16x32_bf16 v[216:219], v[184:187], v[152:155], 0
    s_waitcnt lgkmcnt(12)
    v_mfma_f32_16x16x32_bf16 v[220:223], v[188:191], v[156:159], 0
    s_waitcnt lgkmcnt(10)
    v_mfma_f32_16x16x32_bf16 v[216:219], v[192:195], v[160:163], v[216:219]
    s_waitcnt lgkmcnt(8)
    v_mfma_f32_16x16x32_bf16 v[220:223], v[196:199], v[164:167], v[220:223]
    s_waitcnt lgkmcnt(6)
    v_mfma_f32_16x16x32_bf16 v[216:219], v[200:203], v[168:171], v[216:219]
    s_waitcnt lgkmcnt(4)
    v_mfma_f32_16x16x32_bf16 v[220:223], v[204:207], v[172:175], v[220:223]
    s_waitcnt lgkmcnt(2)
    v_mfma_f32_16x16x32_bf16 v[216:219], v[208:211], v[176:179], v[216:219]
    s_waitcnt lgkmcnt(0)
    v_mfma_f32_16x16x32_bf16 v[220:223], v[212:215], v[180:183], v[220:223]
    s_nop 7
    v_pk_add_f32 v[216:217], v[216:217], v[220:221]
    v_pk_add_f32 v[218:219], v[218:219], v[222:223]
    v_cvt_pk_bf16_f32 v136, v216, v217
    v_cvt_pk_bf16_f32 v138, v218, v219
    s_mov_b32 exec_lo, 0x000F000F
    s_mov_b32 exec_hi, 0x000F000F
    buffer_store_dwordx4 v[136:139], v145, s[8:11], s70 offen sc1
    s_mov_b64 exec, -1
    s_cmp_ge_u32 s71, 43
    s_cbranch_scc1 L_nofgc_2
    v_mov_b32 v56, -1
    v_mov_b32 v57, -1
    v_mov_b32 v58, -1
    v_mov_b32 v59, -1
    v_lshlrev_b32 v60, 4, v1
    s_lshl_b32 s16, s71, 13
    s_add_u32 s16, s16, 5931008
    buffer_store_dwordx4 v[56:59], v60, s[8:11], s16 offen offset:0 sc1
    buffer_store_dwordx4 v[56:59], v60, s[8:11], s16 offen offset:1024 sc1
    buffer_store_dwordx4 v[56:59], v60, s[8:11], s16 offen offset:2048 sc1
    buffer_store_dwordx4 v[56:59], v60, s[8:11], s16 offen offset:3072 sc1
    s_add_u32 s16, s16, 4096
    buffer_store_dwordx4 v[56:59], v60, s[8:11], s16 offen offset:0 sc1
    buffer_store_dwordx4 v[56:59], v60, s[8:11], s16 offen offset:1024 sc1
    buffer_store_dwordx4 v[56:59], v60, s[8:11], s16 offen offset:2048 sc1
    buffer_store_dwordx4 v[56:59], v60, s[8:11], s16 offen offset:3072 sc1
    s_cmp_lg_u32 s71, 0
    s_cbranch_scc1 L_nofgc_2
    s_mov_b32 s16, 6283264
    buffer_store_dwordx4 v[56:59], v60, s[8:11], s16 offen offset:0 sc1
    buffer_store_dwordx4 v[56:59], v60, s[8:11], s16 offen offset:1024 sc1
    buffer_store_dwordx4 v[56:59], v60, s[8:11], s16 offen offset:2048 sc1
    buffer_store_dwordx4 v[56:59], v60, s[8:11], s16 offen offset:3072 sc1
    s_add_u32 s16, s16, 4096
    buffer_store_dwordx4 v[56:59], v60, s[8:11], s16 offen offset:0 sc1
    buffer_store_dwordx4 v[56:59], v60, s[8:11], s16 offen offset:1024 sc1
    buffer_store_dwordx4 v[56:59], v60, s[8:11], s16 offen offset:2048 sc1
    buffer_store_dwordx4 v[56:59], v60, s[8:11], s16 offen offset:3072 sc1
L_nofgc_2:
    s_barrier
    s_lshl_b32 s17, s6, 15
    s_add_u32 m0, s17, 0
    s_nop 0
    buffer_load_dwordx4 v8, s[64:67], s18 offen offset:0  lds
    buffer_load_dwordx4 v9, s[64:67], s18 offen offset:1024  lds
    buffer_load_dwordx4 v10, s[64:67], s18 offen offset:2048  lds
    buffer_load_dwordx4 v11, s[64:67], s18 offen offset:3072  lds
    s_add_u32 s18, s18, 4096
    s_add_u32 m0, m0, 4096
    s_nop 0
    buffer_load_dwordx4 v12, s[64:67], s18 offen offset:0  lds
    buffer_load_dwordx4 v13, s[64:67], s18 offen offset:1024  lds
    buffer_load_dwordx4 v14, s[64:67], s18 offen offset:2048  lds
    buffer_load_dwordx4 v15, s[64:67], s18 offen offset:3072  lds
    s_add_u32 s18, s18, 4096
    s_add_u32 m0, m0, 4096
    s_nop 0
    buffer_load_dwordx4 v16, s[64:67], s18 offen offset:0  lds
    buffer_load_dwordx4 v17, s[64:67], s18 offen offset:1024  lds
    buffer_load_dwordx4 v18, s[64:67], s18 offen offset:2048  lds
    buffer_load_dwordx4 v19, s[64:67], s18 offen offset:3072  lds
    s_add_u32 s18, s18, 4096
    s_add_u32 m0, m0, 4096
    s_nop 0
    buffer_load_dwordx4 v20, s[64:67], s18 offen offset:0  lds
    buffer_load_dwordx4 v21, s[64:67], s18 offen offset:1024  lds
    buffer_load_dwordx4 v22, s[64:67], s18 offen offset:2048  lds
    buffer_load_dwordx4 v23, s[64:67], s18 offen offset:3072  lds
    s_add_u32 s18, s18, 4096
    s_add_u32 m0, m0, 4096
    s_nop 0
    buffer_load_dwordx4 v8, s[64:67], s18 offen offset:0  lds
    buffer_load_dwordx4 v9, s[64:67], s18 offen offset:1024  lds
    buffer_load_dwordx4 v10, s[64:67], s18 offen offset:2048  lds
    buffer_load_dwordx4 v11, s[64:67], s18 offen offset:3072  lds
    s_add_u32 s18, s18, 4096
    s_add_u32 m0, m0, 4096
    s_nop 0
    buffer_load_dwordx4 v12, s[64:67], s18 offen offset:0  lds
    buffer_load_dwordx4 v13, s[64:67], s18 offen offset:1024  lds
    buffer_load_dwordx4 v14, s[64:67], s18 offen offset:2048  lds
    buffer_load_dwordx4 v15, s[64:67], s18 offen offset:3072  lds
    s_add_u32 s18, s18, 4096
    s_add_u32 m0, m0, 4096
    s_nop 0
    buffer_load_dwordx4 v16, s[64:67], s18 offen offset:0  lds
    buffer_load_dwordx4 v17, s[64:67], s18 offen offset:1024  lds
    buffer_load_dwordx4 v18, s[64:67], s18 offen offset:2048  lds
    buffer_load_dwordx4 v19, s[64:67], s18 offen offset:3072  lds
    s_add_u32 s18, s18, 4096
    s_add_u32 m0, m0, 4096
    s_nop 0
    buffer_load_dwordx4 v20, s[64:67], s18 offen offset:0  lds
    buffer_load_dwordx4 v21, s[64:67], s18 offen offset:1024  lds
    buffer_load_dwordx4 v22, s[64:67], s18 offen offset:2048  lds
    buffer_load_dwordx4 v23, s[64:67], s18 offen offset:3072  lds
    s_cmp_ge_u32 s71, 43
    s_cbranch_scc1 L_nocf_3
    s_waitcnt vmcnt(32)
    s_lshl_b32 s16, s2, 7
    s_add_u32 s16, s16, 4096
    v_mov_b32 v60, s5
    s_mov_b32 exec_lo, 1
    s_mov_b32 exec_hi, 0
    buffer_store_dword v60, v3, s[8:11], s16 offen sc1
    s_mov_b64 exec, -1
L_nocf_3:
    s_branch L_A_join
L_A_others:
    v_xor_b32 v8, 0, v1
    v_xor_b32 v9, 4, v1
    v_xor_b32 v10, 8, v1
    v_xor_b32 v11, 12, v1
    v_xor_b32 v12, 1, v1
    v_xor_b32 v13, 5, v1
    v_xor_b32 v14, 9, v1
    v_xor_b32 v15, 13, v1
    v_xor_b32 v16, 2, v1
    v_xor_b32 v17, 6, v1
    v_xor_b32 v18, 10, v1
    v_xor_b32 v19, 14, v1
    v_xor_b32 v20, 3, v1
    v_xor_b32 v21, 7, v1
    v_xor_b32 v22, 11, v1
    v_xor_b32 v23, 15, v1
    v_lshlrev_b32 v8, 4, v8
    v_lshlrev_b32 v9, 4, v9
    v_lshlrev_b32 v10, 4, v10
    v_lshlrev_b32 v11, 4, v11
    v_lshlrev_b32 v12, 4, v12
    v_lshlrev_b32 v13, 4, v13
    v_lshlrev_b32 v14, 4, v14
    v_lshlrev_b32 v15, 4, v15
    v_lshlrev_b32 v16, 4, v16
    v_lshlrev_b32 v17, 4, v17
    v_lshlrev_b32 v18, 4, v18
    v_lshlrev_b32 v19, 4, v19
    v_lshlrev_b32 v20, 4, v20
    v_lshlrev_b32 v21, 4, v21
    v_lshlrev_b32 v22, 4, v22
    v_lshlrev_b32 v23, 4, v23
    s_add_u32 s16, s6, 0
    v_xor_b32 v24, s16, v1
    v_lshlrev_b32 v24, 4, v24
    s_lshl_b32 s16, s16, 10
    s_add_u32 s16, s16, 131072
    v_add_u32 v24, s16, v24
    s_add_u32 s16, s6, 4
    v_xor_b32 v25, s16, v1
    v_lshlrev_b32 v25, 4, v25
    s_lshl_b32 s16, s16, 10
    s_add_u32 s16, s16, 131072
    v_add_u32 v25, s16, v25
    s_add_u32 s16, s6, 8
    v_xor_b32 v26, s16, v1
    v_lshlrev_b32 v26, 4, v26
    s_lshl_b32 s16, s16, 10
    s_add_u32 s16, s16, 131072
    v_add_u32 v26, s16, v26
    s_add_u32 s16, s6, 12
    v_xor_b32 v27, s16, v1
    v_lshlrev_b32 v27, 4, v27
    s_lshl_b32 s16, s16, 10
    s_add_u32 s16, s16, 131072
    v_add_u32 v27, s16, v27
    v_and_b32 v36, 15, v1
    v_lshrrev_b32 v37, 5, v1
    v_xor_b32 v36, v36, v37
    v_lshlrev_b32 v36, 4, v36
    v_and_b32 v37, 31, v1
    v_lshlrev_b32 v37, 10, v37
    v_add_u32 v37, 131072, v37
    v_add_u32 v36, v36, v37
    v_xor_b32 v28, 0, v36
    v_xor_b32 v29, 32, v36
    v_xor_b32 v30, 64, v36
    v_xor_b32 v31, 96, v36
    v_xor_b32 v32, 128, v36
    v_xor_b32 v33, 160, v36
    v_xor_b32 v34, 192, v36
    v_xor_b32 v35, 224, v36
    v_and_b32 v44, 3, v1
    v_lshlrev_b32 v44, 2, v44
    v_bfe_u32 v45, v1, 2, 2
    v_or_b32 v44, v44, v45
    v_lshrrev_b32 v45, 5, v1
    v_xor_b32 v44, v44, v45
    v_lshlrev_b32 v44, 4, v44
    v_and_b32 v45, 31, v1
    v_lshlrev_b32 v45, 10, v45
    s_lshl_b32 s16, s6, 15
    s_add_u32 s16, s16, 0
    v_add_u32 v45, s16, v45
    v_add_u32 v44, v44, v45
    v_xor_b32 v36, 0, v44
    v_xor_b32 v37, 32, v44
    v_xor_b32 v38, 64, v44
    v_xor_b32 v39, 96, v44
    v_xor_b32 v40, 128, v44
    v_xor_b32 v41, 160, v44
    v_xor_b32 v42, 192, v44
    v_xor_b32 v43, 224, v44
    v_lshrrev_b32 v44, 5, v1
    v_bfe_u32 v45, v1, 2, 2
    v_bfe_u32 v46, v1, 4, 1
    v_bfe_u32 v47, v1, 1, 1
    v_lshl_or_b32 v46, v46, 1, v47
    v_xor_b32 v46, v46, v44
    v_lshl_or_b32 v46, v45, 2, v46
    v_lshlrev_b32 v46, 4, v46
    v_lshl_add_u32 v44, v44, 2, v45
    v_lshlrev_b32 v44, 10, v44
    v_and_b32 v45, 1, v1
    v_lshl_add_u32 v44, v45, 3, v44
    s_lshl_b32 s16, s6, 8
    s_add_u32 s16, s16, 0
    v_add_u32 v44, s16, v44
    v_add_u32 v44, v44, v46
    v_xor_b32 v232, 0, v44
    v_add_u32 v240, 0x10000, v232
    v_xor_b32 v233, 32, v44
    v_add_u32 v241, 0x10000, v233
    v_xor_b32 v234, 64, v44
    v_add_u32 v242, 0x10000, v234
    v_xor_b32 v235, 96, v44
    v_add_u32 v243, 0x10000, v235
    v_xor_b32 v236, 128, v44
    v_add_u32 v244, 0x10000, v236
    v_xor_b32 v237, 160, v44
    v_add_u32 v245, 0x10000, v237
    v_xor_b32 v238, 192, v44
    v_add_u32 v246, 0x10000, v238
    v_xor_b32 v239, 224, v44
    v_add_u32 v247, 0x10000, v239
    s_lshl_b32 s16, s12, 15
    s_lshl_b32 s17, s6, 10
    s_add_u32 s16, s16, s17
    s_add_u32 s24, s16, 393216
    s_add_u32 s25, s24, 4096
    s_add_u32 s26, s25, 4096
    s_add_u32 s27, s26, 4096
    s_add_u32 s28, s27, 4096
    s_add_u32 s29, s28, 4096
    s_add_u32 s30, s29, 4096
    s_add_u32 s31, s30, 4096
    v_lshlrev_b32 v48, 4, v1
    v_lshrrev_b32 v49, 5, v1
    s_mov_b32 s16, 593920
    v_mul_lo_u32 v49, v49, s16
    v_and_b32 v50, 31, v1
    v_lshl_add_u32 v49, v50, 2, v49
    v_lshlrev_b32 v50, 4, v50
    v_add_u32 v51, 131072, v50
    s_lshl_b32 s16, s6, 2
    v_add_u32 v50, s16, v51
    v_add_u32 v53, 132096, v48
    s_lshl_b32 s16, s6, 11
    v_add_u32 v52, s16, v53
    s_mul_i32 s20, s6, 37120
    s_lshl_b32 s16, s12, 13
    s_add_u32 s20, s20, s16
    s_lshl_b32 s16, s4, 8
    s_add_u32 s20, s20, s16
    s_add_u32 s20, s20, 1048576
    s_lshl_b32 s21, s12, 5
    s_add_u32 s21, s21, s4
    s_lshl_b32 s21, s21, 9
    s_add_u32 s21, s21, 524288
    s_lshl_b32 s22, s6, 2
    s_add_u32 s22, s22, s12
    s_lshl_b32 s22, s22, 5
    s_add_u32 s22, s22, s4
    s_lshl_b32 s22, s22, 7
    s_add_u32 s22, s22, 983040
    v_bfe_u32 v54, v1, 2, 3
    v_and_b32 v55, 1, v54
    v_lshlrev_b32 v55, 2, v55
    v_add_u32 v55, s6, v55
    v_and_b32 v56, 3, v1
    v_lshl_add_u32 v55, v55, 2, v56
    v_lshlrev_b32 v55, 3, v55
    v_and_b32 v54, 6, v54
    v_add3_u32 v55, v55, v54, 1
    v_lshlrev_b32 v55, 7, v55
    s_waitcnt lgkmcnt(0)
    buffer_load_dword v4, v3, s[8:11], 0 offen sc1
    v_mov_b32 v56, -1
    v_mov_b32 v57, -1
    v_mov_b32 v58, -1
    v_mov_b32 v59, -1
    v_lshrrev_b32 v60, 4, v1
    s_mov_b32 s16, 37120
    v_mul_lo_u32 v60, v60, s16
    v_and_b32 v61, 15, v1
    v_lshl_add_u32 v60, v61, 4, v60
    s_sub_u32 s17, s6, 1
    s_mul_i32 s16, s17, 148480
    s_lshl_b32 s17, s12, 13
    s_add_u32 s16, s16, s17
    s_lshl_b32 s17, s4, 8
    s_add_u32 s16, s16, s17
    s_add_u32 s16, s16, 1048576
    buffer_store_dwordx4 v[56:59], v60, s[8:11], s16 offen sc1
    s_add_u32 s16, s16, 445440
    buffer_store_dwordx4 v[56:59], v60, s[8:11], s16 offen sc1
    s_add_u32 s16, s16, 445440
    buffer_store_dwordx4 v[56:59], v60, s[8:11], s16 offen sc1
    s_add_u32 s16, s16, 445440
    buffer_store_dwordx4 v[56:59], v60, s[8:11], s16 offen sc1
    s_add_u32 s16, s16, 445440
    buffer_store_dwordx4 v[56:59], v60, s[8:11], s16 offen sc1
    s_add_u32 s16, s16, 445440
    buffer_store_dwordx4 v[56:59], v60, s[8:11], s16 offen sc1
    s_add_u32 s16, s16, 445440
    buffer_store_dwordx4 v[56:59], v60, s[8:11], s16 offen sc1
    s_add_u32 s16, s16, 445440
    buffer_store_dwordx4 v[56:59], v60, s[8:11], s16 offen sc1
    s_add_u32 s16, s16, 445440
    buffer_store_dwordx4 v[56:59], v60, s[8:11], s16 offen sc1
    s_add_u32 s16, s16, 445440
    buffer_store_dwordx4 v[56:59], v60, s[8:11], s16 offen sc1
    s_add_u32 s16, s16, 445440
    s_cmp_eq_u32 s6, 3
    s_cbranch_scc1 L_clrd_4
    buffer_store_dwordx4 v[56:59], v60, s[8:11], s16 offen sc1
L_clrd_4:
    s_lshl_b32 s17, s6, 15
    s_add_u32 m0, s17, 0
    s_barrier
    buffer_load_dwordx4 v8, s[64:67], s18 offen offset:0  lds
    buffer_load_dwordx4 v9, s[64:67], s18 offen offset:1024  lds
    buffer_load_dwordx4 v10, s[64:67], s18 offen offset:2048  lds
    buffer_load_dwordx4 v11, s[64:67], s18 offen offset:3072  lds
    s_add_u32 s18, s18, 4096
    s_add_u32 m0, m0, 4096
    s_nop 0
    buffer_load_dwordx4 v12, s[64:67], s18 offen offset:0  lds
    buffer_load_dwordx4 v13, s[64:67], s18 offen offset:1024  lds
    buffer_load_dwordx4 v14, s[64:67], s18 offen offset:2048  lds
    buffer_load_dwordx4 v15, s[64:67], s18 offen offset:3072  lds
    s_add_u32 s18, s18, 4096
    s_add_u32 m0, m0, 4096
    s_nop 0
    buffer_load_dwordx4 v16, s[64:67], s18 offen offset:0  lds
    buffer_load_dwordx4 v17, s[64:67], s18 offen offset:1024  lds
    buffer_load_dwordx4 v18, s[64:67], s18 offen offset:2048  lds
    buffer_load_dwordx4 v19, s[64:67], s18 offen offset:3072  lds
    s_add_u32 s18, s18, 4096
    s_add_u32 m0, m0, 4096
    s_nop 0
    buffer_load_dwordx4 v20, s[64:67], s18 offen offset:0  lds
    buffer_load_dwordx4 v21, s[64:67], s18 offen offset:1024  lds
    buffer_load_dwordx4 v22, s[64:67], s18 offen offset:2048  lds
    buffer_load_dwordx4 v23, s[64:67], s18 offen offset:3072  lds
    s_add_u32 s18, s18, 4096
    s_add_u32 m0, m0, 4096
    s_nop 0
    buffer_load_dwordx4 v8, s[64:67], s18 offen offset:0  lds
    buffer_load_dwordx4 v9, s[64:67], s18 offen offset:1024  lds
    buffer_load_dwordx4 v10, s[64:67], s18 offen offset:2048  lds
    buffer_load_dwordx4 v11, s[64:67], s18 offen offset:3072  lds
    s_add_u32 s18, s18, 4096
    s_add_u32 m0, m0, 4096
    s_nop 0
    buffer_load_dwordx4 v12, s[64:67], s18 offen offset:0  lds
    buffer_load_dwordx4 v13, s[64:67], s18 offen offset:1024  lds
    buffer_load_dwordx4 v14, s[64:67], s18 offen offset:2048  lds
    buffer_load_dwordx4 v15, s[64:67], s18 offen offset:3072  lds
    s_add_u32 s18, s18, 4096
    s_add_u32 m0, m0, 4096
    s_nop 0
    buffer_load_dwordx4 v16, s[64:67], s18 offen offset:0  lds
    buffer_load_dwordx4 v17, s[64:67], s18 offen offset:1024  lds
    buffer_load_dwordx4 v18, s[64:67], s18 offen offset:2048  lds
    buffer_load_dwordx4 v19, s[64:67], s18 offen offset:3072  lds
    s_add_u32 s18, s18, 4096
    s_add_u32 m0, m0, 4096
    s_nop 0
    buffer_load_dwordx4 v20, s[64:67], s18 offen offset:0  lds
    buffer_load_dwordx4 v21, s[64:67], s18 offen offset:1024  lds
    buffer_load_dwordx4 v22, s[64:67], s18 offen offset:2048  lds
    buffer_load_dwordx4 v23, s[64:67], s18 offen offset:3072  lds
    s_waitcnt vmcnt(32)
    v_readfirstlane_b32 s5, v4
    s_mul_i32 s5, s5, 2654435761
    s_add_u32 s5, s5, 2135587861
L_A_join:
    s_mov_b32 s16, 4096
    s_mov_b32 s7, 0
L_poll_8:
    buffer_load_dword v56, v55, s[8:11], s16 offen sc1
    s_waitcnt vmcnt(0)
    v_cmp_ne_u32 vcc, s5, v56
    s_cbranch_vccz L_pdone_9
    s_sleep 2
    s_add_u32 s7, s7, 1
    s_cmp_lt_u32 s7, 400000
    s_cbranch_scc1 L_poll_8
L_pdone_9:
    ds_read_b128 a[0:3], v36 offset:0
    ds_read_b128 a[4:7], v37 offset:0
    ds_read_b128 a[8:11], v38 offset:0
    ds_read_b128 a[12:15], v39 offset:0
    ds_read_b128 a[16:19], v40 offset:0
    ds_read_b128 a[20:23], v41 offset:0
    ds_read_b128 a[24:27], v42 offset:0
    ds_read_b128 a[28:31], v43 offset:0
    ds_read_b128 a[32:35], v36 offset:256
    ds_read_b128 a[36:39], v37 offset:256
    ds_read_b128 a[40:43], v38 offset:256
    ds_read_b128 a[44:47], v39 offset:256
    ds_read_b128 a[48:51], v40 offset:256
    ds_read_b128 a[52:55], v41 offset:256
    ds_read_b128 a[56:59], v42 offset:256
    ds_read_b128 a[60:63], v43 offset:256
    ds_read_b128 a[64:67], v36 offset:512
    ds_read_b128 a[68:71], v37 offset:512
    ds_read_b128 a[72:75], v38 offset:512
    ds_read_b128 a[76:79], v39 offset:512
    ds_read_b128 a[80:83], v40 offset:512
    ds_read_b128 a[84:87], v41 offset:512
    ds_read_b128 a[88:91], v42 offset:512
    ds_read_b128 a[92:95], v43 offset:512
    ds_read_b128 a[96:99], v36 offset:768
    ds_read_b128 a[100:103], v37 offset:768
    ds_read_b128 a[104:107], v38 offset:768
    ds_read_b128 a[108:111], v39 offset:768
    ds_read_b128 a[112:115], v40 offset:768
    ds_read_b128 a[116:119], v41 offset:768
    ds_read_b128 a[120:123], v42 offset:768
    ds_read_b128 a[124:127], v43 offset:768
L_pre_7:
    s_mov_b32 s7, 0
L_poll_10:
    buffer_load_dwordx4 v[64:67], v48, s[8:11], s24 offen sc1
    buffer_load_dwordx4 v[68:71], v48, s[8:11], s25 offen sc1
    buffer_load_dwordx4 v[72:75], v48, s[8:11], s26 offen sc1
    buffer_load_dwordx4 v[76:79], v48, s[8:11], s27 offen sc1
    buffer_load_dwordx4 v[80:83], v48, s[8:11], s28 offen sc1
    buffer_load_dwordx4 v[84:87], v48, s[8:11], s29 offen sc1
    buffer_load_dwordx4 v[88:91], v48, s[8:11], s30 offen sc1
    buffer_load_dwordx4 v[92:95], v48, s[8:11], s31 offen sc1
    s_waitcnt vmcnt(0)
    v_max3_u32 v54, v64, v65, v66
    v_max3_u32 v54, v54, v67, v68
    v_max3_u32 v54, v54, v69, v70
    v_max3_u32 v54, v54, v71, v72
    v_max3_u32 v54, v54, v73, v74
    v_max3_u32 v54, v54, v75, v76
    v_max3_u32 v54, v54, v77, v78
    v_max3_u32 v54, v54, v79, v80
    v_max3_u32 v54, v54, v81, v82
    v_max3_u32 v54, v54, v83, v84
    v_max3_u32 v54, v54, v85, v86
    v_max3_u32 v54, v54, v87, v88
    v_max3_u32 v54, v54, v89, v90
    v_max3_u32 v54, v54, v91, v92
    v_max3_u32 v54, v54, v93, v94
    v_max_u32 v54, v54, v95
    v_cmp_eq_u32 vcc, -1, v54
    s_cbranch_vccz L_pdone_11
    s_add_u32 s7, s7, 1
    s_cmp_lt_u32 s7, 400000
    s_cbranch_scc1 L_poll_10
L_pdone_11:
L_x3ok_5:
    ds_write_b128 v24, v[64:67] offset:0
    ds_write_b128 v25, v[68:71] offset:0
    ds_write_b128 v26, v[72:75] offset:0
    ds_write_b128 v27, v[76:79] offset:0
    ds_write_b128 v24, v[80:83] offset:16384
    ds_write_b128 v25, v[84:87] offset:16384
    ds_write_b128 v26, v[88:91] offset:16384
    ds_write_b128 v27, v[92:95] offset:16384
    s_waitcnt lgkmcnt(0)
    s_barrier
    ds_read_b128 v[112:115], v28 offset:0
    ds_read_b128 v[116:119], v29 offset:0
    ds_read_b128 v[120:123], v30 offset:0
    ds_read_b128 v[124:127], v31 offset:0
    ds_read_b128 v[128:131], v32 offset:0
    ds_read_b128 v[132:135], v33 offset:0
    ds_read_b128 v[136:139], v34 offset:0
    ds_read_b128 v[140:143], v35 offset:0
    s_waitcnt lgkmcnt(7)
    v_mfma_f32_32x32x16_bf16 v[96:111], a[0:3], v[112:115], 0
    ds_read_b128 v[112:115], v28 offset:256
    s_waitcnt lgkmcnt(7)
    v_mfma_f32_32x32x16_bf16 v[96:111], a[4:7], v[116:119], v[96:111]
    ds_read_b128 v[116:119], v29 offset:256
    s_waitcnt lgkmcnt(7)
    v_mfma_f32_32x32x16_bf16 v[96:111], a[8:11], v[120:123], v[96:111]
    ds_read_b128 v[120:123], v30 offset:256
    s_waitcnt lgkmcnt(7)
    v_mfma_f32_32x32x16_bf16 v[96:111], a[12:15], v[124:127], v[96:111]
    ds_read_b128 v[124:127], v31 offset:256
    s_waitcnt lgkmcnt(7)
    v_mfma_f32_32x32x16_bf16 v[96:111], a[16:19], v[128:131], v[96:111]
    ds_read_b128 v[128:131], v32 offset:256
    s_waitcnt lgkmcnt(7)
    v_mfma_f32_32x32x16_bf16 v[96:111], a[20:23], v[132:135], v[96:111]
    ds_read_b128 v[132:135], v33 offset:256
    s_waitcnt lgkmcnt(7)
    v_mfma_f32_32x32x16_bf16 v[96:111], a[24:27], v[136:139], v[96:111]
    ds_read_b128 v[136:139], v34 offset:256
    s_waitcnt lgkmcnt(7)
    v_mfma_f32_32x32x16_bf16 v[96:111], a[28:31], v[140:143], v[96:111]
    ds_read_b128 v[140:143], v35 offset:256
    s_waitcnt lgkmcnt(7)
    v_mfma_f32_32x32x16_bf16 v[96:111], a[32:35], v[112:115], v[96:111]
    ds_read_b128 v[112:115], v28 offset:512
    s_waitcnt lgkmcnt(7)
    v_mfma_f32_32x32x16_bf16 v[96:111], a[36:39], v[116:119], v[96:111]
    ds_read_b128 v[116:119], v29 offset:512
    s_waitcnt lgkmcnt(7)
    v_mfma_f32_32x32x16_bf16 v[96:111], a[40:43], v[120:123], v[96:111]
    ds_read_b128 v[120:123], v30 offset:512
    s_waitcnt lgkmcnt(7)
    v_mfma_f32_32x32x16_bf16 v[96:111], a[44:47], v[124:127], v[96:111]
    ds_read_b128 v[124:127], v31 offset:512
    s_waitcnt lgkmcnt(7)
    v_mfma_f32_32x32x16_bf16 v[96:111], a[48:51], v[128:131], v[96:111]
    ds_read_b128 v[128:131], v32 offset:512
    s_waitcnt lgkmcnt(7)
    v_mfma_f32_32x32x16_bf16 v[96:111], a[52:55], v[132:135], v[96:111]
    ds_read_b128 v[132:135], v33 offset:512
    s_waitcnt lgkmcnt(7)
    v_mfma_f32_32x32x16_bf16 v[96:111], a[56:59], v[136:139], v[96:111]
    ds_read_b128 v[136:139], v34 offset:512
    s_waitcnt lgkmcnt(7)
    v_mfma_f32_32x32x16_bf16 v[96:111], a[60:63], v[140:143], v[96:111]
    ds_read_b128 v[140:143], v35 offset:512
    s_waitcnt lgkmcnt(7)
    v_mfma_f32_32x32x16_bf16 v[96:111], a[64:67], v[112:115], v[96:111]
    ds_read_b128 v[112:115], v28 offset:768
    s_waitcnt lgkmcnt(7)
    v_mfma_f32_32x32x16_bf16 v[96:111], a[68:71], v[116:119], v[96:111]
    ds_read_b128 v[116:119], v29 offset:768
    s_waitcnt lgkmcnt(7)
    v_mfma_f32_32x32x16_bf16 v[96:111], a[72:75], v[120:123], v[96:111]
    ds_read_b128 v[120:123], v30 offset:768
    s_waitcnt lgkmcnt(7)
    v_mfma_f32_32x32x16_bf16 v[96:111], a[76:79], v[124:127], v[96:111]
    ds_read_b128 v[124:127], v31 offset:768
    s_waitcnt lgkmcnt(7)
    v_mfma_f32_32x32x16_bf16 v[96:111], a[80:83], v[128:131], v[96:111]
    ds_read_b128 v[128:131], v32 offset:768
    s_waitcnt lgkmcnt(7)
    v_mfma_f32_32x32x16_bf16 v[96:111], a[84:87], v[132:135], v[96:111]
    ds_read_b128 v[132:135], v33 offset:768
    s_waitcnt lgkmcnt(7)
    v_mfma_f32_32x32x16_bf16 v[96:111], a[88:91], v[136:139], v[96:111]
    ds_read_b128 v[136:139], v34 offset:768
    s_waitcnt lgkmcnt(7)
    v_mfma_f32_32x32x16_bf16 v[96:111], a[92:95], v[140:143], v[96:111]
    ds_read_b128 v[140:143], v35 offset:768
    s_waitcnt lgkmcnt(7)
    v_mfma_f32_32x32x16_bf16 v[96:111], a[96:99], v[112:115], v[96:111]
    s_waitcnt lgkmcnt(6)
    v_mfma_f32_32x32x16_bf16 v[96:111], a[100:103], v[116:119], v[96:111]
    s_waitcnt lgkmcnt(5)
    v_mfma_f32_32x32x16_bf16 v[96:111], a[104:107], v[120:123], v[96:111]
    s_waitcnt lgkmcnt(4)
    v_mfma_f32_32x32x16_bf16 v[96:111], a[108:111], v[124:127], v[96:111]
    s_waitcnt lgkmcnt(0)
    s_barrier
    v_mfma_f32_32x32x16_bf16 v[96:111], a[112:115], v[128:131], v[96:111]
    v_mfma_f32_32x32x16_bf16 v[96:111], a[116:119], v[132:135], v[96:111]
    v_mfma_f32_32x32x16_bf16 v[96:111], a[120:123], v[136:139], v[96:111]
    v_mfma_f32_32x32x16_bf16 v[96:111], a[124:127], v[140:143], v[96:111]
    s_nop 11
    v_max3_f32 v54, v96, v97, v98
    v_max3_f32 v55, v99, v100, v101
    v_max3_f32 v56, v102, v103, v104
    v_max3_f32 v57, v105, v106, v107
    v_max3_f32 v54, v54, v108, v109
    v_max3_f32 v55, v55, v110, v111
    v_max3_f32 v54, v54, v55, v56
    v_max_f32 v54, v54, v57
    v_mov_b32 v55, v54
    s_nop 1
    v_permlane32_swap_b32 v54, v55
    v_max_f32 v54, v54, v55
    ds_write_b32 v50, v54
    s_waitcnt lgkmcnt(0)
    s_barrier
    ds_read_b128 v[56:59], v51
    s_mov_b32 s16, 1040356334
    s_mov_b32 s17, 1040356334
    v_pk_mul_f32 v[96:97], v[96:97], s[16:17]
    v_pk_mul_f32 v[98:99], v[98:99], s[16:17]
    v_pk_mul_f32 v[100:101], v[100:101], s[16:17]
    v_pk_mul_f32 v[102:103], v[102:103], s[16:17]
    v_pk_mul_f32 v[104:105], v[104:105], s[16:17]
    v_pk_mul_f32 v[106:107], v[106:107], s[16:17]
    v_pk_mul_f32 v[108:109], v[108:109], s[16:17]
    v_pk_mul_f32 v[110:111], v[110:111], s[16:17]
    s_waitcnt lgkmcnt(0)
    v_max3_f32 v54, v56, v57, v58
    v_max_f32 v54, v54, v59
    v_mul_f32 v56, s16, v54
    v_mov_b32 v57, v56
    v_pk_add_f32 v[96:97], v[96:97], v[56:57] neg_lo:[0,1] neg_hi:[0,1]
    v_pk_add_f32 v[98:99], v[98:99], v[56:57] neg_lo:[0,1] neg_hi:[0,1]
    v_pk_add_f32 v[100:101], v[100:101], v[56:57] neg_lo:[0,1] neg_hi:[0,1]
    v_pk_add_f32 v[102:103], v[102:103], v[56:57] neg_lo:[0,1] neg_hi:[0,1]
    v_exp_f32 v96, v96
    v_exp_f32 v97, v97
    v_exp_f32 v98, v98
    v_exp_f32 v99, v99
    v_exp_f32 v100, v100
    v_exp_f32 v101, v101
    v_exp_f32 v102, v102
    v_exp_f32 v103, v103
    v_pk_add_f32 v[104:105], v[104:105], v[56:57] neg_lo:[0,1] neg_hi:[0,1]
    v_pk_add_f32 v[106:107], v[106:107], v[56:57] neg_lo:[0,1] neg_hi:[0,1]
    v_pk_add_f32 v[108:109], v[108:109], v[56:57] neg_lo:[0,1] neg_hi:[0,1]
    v_pk_add_f32 v[110:111], v[110:111], v[56:57] neg_lo:[0,1] neg_hi:[0,1]
    v_cvt_pk_bf16_f32 v60, v96, v97
    v_cvt_pk_bf16_f32 v61, v98, v99
    v_cvt_pk_bf16_f32 v62, v100, v101
    v_cvt_pk_bf16_f32 v63, v102, v103
    ds_write_b128 v52, v[60:63]
    v_exp_f32 v104, v104
    v_exp_f32 v105, v105
    v_exp_f32 v106, v106
    v_exp_f32 v107, v107
    v_exp_f32 v108, v108
    v_exp_f32 v109, v109
    v_exp_f32 v110, v110
    v_exp_f32 v111, v111
    v_cvt_pk_bf16_f32 v112, v104, v105
    v_cvt_pk_bf16_f32 v113, v106, v107
    v_cvt_pk_bf16_f32 v114, v108, v109
    v_cvt_pk_bf16_f32 v115, v110, v111
    ds_write_b128 v52, v[112:115] offset:1024
    s_waitcnt lgkmcnt(0)
    s_barrier
    ds_read_b128 v[64:67], v53
    ds_read_b64_tr_b16 v[208:209], v232 offset:0
    ds_read_b64_tr_b16 v[210:211], v233 offset:8192
    ds_read_b64_tr_b16 v[212:213], v234 offset:0
    ds_read_b64_tr_b16 v[214:215], v235 offset:8192
    ds_read_b128 v[68:71], v53 offset:1024
    ds_read_b64_tr_b16 v[216:217], v232 offset:16384
    ds_read_b64_tr_b16 v[218:219], v233 offset:24576
    ds_read_b64_tr_b16 v[220:221], v234 offset:16384
    ds_read_b64_tr_b16 v[222:223], v235 offset:24576
    ds_read_b128 v[72:75], v53 offset:2048
    ds_read_b128 v[76:79], v53 offset:3072
    ds_read_b128 v[80:83], v53 offset:4096
    ds_read_b128 v[84:87], v53 offset:5120
    ds_read_b128 v[88:91], v53 offset:6144
    ds_read_b128 v[92:95], v53 offset:7168
    ds_read_b64_tr_b16 v[224:225], v232 offset:32768
    ds_read_b64_tr_b16 v[226:227], v233 offset:40960
    ds_read_b64_tr_b16 v[228:229], v234 offset:32768
    ds_read_b64_tr_b16 v[230:231], v235 offset:40960
    s_add_u32 s24, s20, 0
    s_add_u32 s25, s20, 148480
    s_add_u32 s26, s20, 296960
    s_add_u32 s27, s20, 445440
    s_add_u32 s28, s20, 1187840
    s_add_u32 s29, s20, 1336320
    s_add_u32 s30, s20, 1484800
    s_add_u32 s31, s20, 1633280
    s_add_u32 s32, s20, 2375680
    s_add_u32 s33, s20, 2524160
    s_add_u32 s34, s20, 2672640
    s_add_u32 s35, s20, 2821120
    s_add_u32 s36, s20, 3563520
    s_add_u32 s37, s20, 3712000
    s_add_u32 s38, s20, 3860480
    s_add_u32 s39, s20, 4008960
    v_mov_b32 v116, 0
    v_mov_b32 v117, 0
    s_mov_b32 s18, 0x3f803f80
    s_waitcnt lgkmcnt(15)
    v_mfma_f32_32x32x16_bf16 v[144:159], v[64:67], v[208:211], 0
    ds_read_b64_tr_b16 v[208:209], v232 offset:49152
    ds_read_b64_tr_b16 v[210:211], v233 offset:57344
    s_waitcnt lgkmcnt(15)
    v_mfma_f32_32x32x16_bf16 v[160:175], v[64:67], v[212:215], 0
    ds_read_b64_tr_b16 v[212:213], v234 offset:49152
    ds_read_b64_tr_b16 v[214:215], v235 offset:57344
    s_waitcnt lgkmcnt(15)
    v_mfma_f32_32x32x16_bf16 v[144:159], v[68:71], v[216:219], v[144:159]
    ds_read_b64_tr_b16 v[216:217], v240 offset:0
    ds_read_b64_tr_b16 v[218:219], v241 offset:8192
    v_dot2_f32_bf16 v116, v64, s18, v116
    v_dot2_f32_bf16 v117, v65, s18, v117
    s_waitcnt lgkmcnt(15)
    v_mfma_f32_32x32x16_bf16 v[160:175], v[68:71], v[220:223], v[160:175]
    ds_read_b64_tr_b16 v[220:221], v242 offset:0
    ds_read_b64_tr_b16 v[222:223], v243 offset:8192
    v_dot2_f32_bf16 v116, v66, s18, v116
    v_dot2_f32_bf16 v117, v67, s18, v117
    s_waitcnt lgkmcnt(10)
    v_mfma_f32_32x32x16_bf16 v[144:159], v[72:75], v[224:227], v[144:159]
    ds_read_b64_tr_b16 v[224:225], v240 offset:16384
    ds_read_b64_tr_b16 v[226:227], v241 offset:24576
    v_dot2_f32_bf16 v116, v68, s18, v116
    v_dot2_f32_bf16 v117, v69, s18, v117
    s_waitcnt lgkmcnt(10)
    v_mfma_f32_32x32x16_bf16 v[160:175], v[72:75], v[228:231], v[160:175]
    ds_read_b64_tr_b16 v[228:229], v242 offset:16384
    ds_read_b64_tr_b16 v[230:231], v243 offset:24576
    v_dot2_f32_bf16 v116, v70, s18, v116
    v_dot2_f32_bf16 v117, v71, s18, v117
    s_waitcnt lgkmcnt(10)
    v_mfma_f32_32x32x16_bf16 v[144:159], v[76:79], v[208:211], v[144:159]
    ds_read_b64_tr_b16 v[208:209], v240 offset:32768
    ds_read_b64_tr_b16 v[210:211], v241 offset:40960
    v_dot2_f32_bf16 v116, v72, s18, v116
    v_dot2_f32_bf16 v117, v73, s18, v117
    s_waitcnt lgkmcnt(10)
    v_mfma_f32_32x32x16_bf16 v[160:175], v[76:79], v[212:215], v[160:175]
    ds_read_b64_tr_b16 v[212:213], v242 offset:32768
    ds_read_b64_tr_b16 v[214:215], v243 offset:40960
    v_dot2_f32_bf16 v116, v74, s18, v116
    v_dot2_f32_bf16 v117, v75, s18, v117
    s_waitcnt lgkmcnt(10)
    v_mfma_f32_32x32x16_bf16 v[144:159], v[80:83], v[216:219], v[144:159]
    ds_read_b64_tr_b16 v[216:217], v240 offset:49152
    ds_read_b64_tr_b16 v[218:219], v241 offset:57344
    v_dot2_f32_bf16 v116, v76, s18, v116
    v_dot2_f32_bf16 v117, v77, s18, v117
    s_waitcnt lgkmcnt(10)
    v_mfma_f32_32x32x16_bf16 v[160:175], v[80:83], v[220:223], v[160:175]
    ds_read_b64_tr_b16 v[220:221], v242 offset:49152
    ds_read_b64_tr_b16 v[222:223], v243 offset:57344
    v_dot2_f32_bf16 v116, v78, s18, v116
    v_dot2_f32_bf16 v117, v79, s18, v117
    s_waitcnt lgkmcnt(10)
    v_mfma_f32_32x32x16_bf16 v[144:159], v[84:87], v[224:227], v[144:159]
    ds_read_b64_tr_b16 v[224:225], v236 offset:0
    ds_read_b64_tr_b16 v[226:227], v237 offset:8192
    v_dot2_f32_bf16 v116, v80, s18, v116
    v_dot2_f32_bf16 v117, v81, s18, v117
    s_waitcnt lgkmcnt(10)
    v_mfma_f32_32x32x16_bf16 v[160:175], v[84:87], v[228:231], v[160:175]
    ds_read_b64_tr_b16 v[228:229], v238 offset:0
    ds_read_b64_tr_b16 v[230:231], v239 offset:8192
    v_dot2_f32_bf16 v116, v82, s18, v116
    v_dot2_f32_bf16 v117, v83, s18, v117
    s_waitcnt lgkmcnt(10)
    v_mfma_f32_32x32x16_bf16 v[144:159], v[88:91], v[208:211], v[144:159]
    ds_read_b64_tr_b16 v[208:209], v236 offset:16384
    ds_read_b64_tr_b16 v[210:211], v237 offset:24576
    v_dot2_f32_bf16 v116, v84, s18, v116
    v_dot2_f32_bf16 v117, v85, s18, v117
    s_waitcnt lgkmcnt(10)
    v_mfma_f32_32x32x16_bf16 v[160:175], v[88:91], v[212:215], v[160:175]
    ds_read_b64_tr_b16 v[212:213], v238 offset:16384
    ds_read_b64_tr_b16 v[214:215], v239 offset:24576
    v_dot2_f32_bf16 v116, v86, s18, v116
    v_dot2_f32_bf16 v117, v87, s18, v117
    s_waitcnt lgkmcnt(10)
    v_mfma_f32_32x32x16_bf16 v[144:159], v[92:95], v[216:219], v[144:159]
    ds_read_b64_tr_b16 v[216:217], v236 offset:32768
    ds_read_b64_tr_b16 v[218:219], v237 offset:40960
    v_dot2_f32_bf16 v116, v88, s18, v116
    v_dot2_f32_bf16 v117, v89, s18, v117
    s_waitcnt lgkmcnt(10)
    v_mfma_f32_32x32x16_bf16 v[160:175], v[92:95], v[220:223], v[160:175]
    ds_read_b64_tr_b16 v[220:221], v238 offset:32768
    ds_read_b64_tr_b16 v[222:223], v239 offset:40960
    v_dot2_f32_bf16 v116, v90, s18, v116
    v_dot2_f32_bf16 v117, v91, s18, v117
    s_waitcnt lgkmcnt(10)
    v_mfma_f32_32x32x16_bf16 v[176:191], v[64:67], v[224:227], 0
    ds_read_b64_tr_b16 v[224:225], v236 offset:49152
    ds_read_b64_tr_b16 v[226:227], v237 offset:57344
    v_dot2_f32_bf16 v116, v92, s18, v116
    v_dot2_f32_bf16 v117, v93, s18, v117
    s_waitcnt lgkmcnt(10)
    v_mfma_f32_32x32x16_bf16 v[192:207], v[64:67], v[228:231], 0
    ds_read_b64_tr_b16 v[228:229], v238 offset:49152
    ds_read_b64_tr_b16 v[230:231], v239 offset:57344
    v_dot2_f32_bf16 v116, v94, s18, v116
    v_dot2_f32_bf16 v117, v95, s18, v117
    s_waitcnt lgkmcnt(10)
    v_mfma_f32_32x32x16_bf16 v[176:191], v[68:71], v[208:211], v[176:191]
    ds_read_b64_tr_b16 v[208:209], v244 offset:0
    ds_read_b64_tr_b16 v[210:211], v245 offset:8192
    v_add_f32 v116, v116, v117
    v_mov_b32 v117, v116
    s_nop 1
    v_permlane32_swap_b32 v116, v117
    v_add_f32 v116, v116, v117
    s_waitcnt lgkmcnt(10)
    v_mfma_f32_32x32x16_bf16 v[192:207], v[68:71], v[212:215], v[192:207]
    ds_read_b64_tr_b16 v[212:213], v246 offset:0
    ds_read_b64_tr_b16 v[214:215], v247 offset:8192
    s_cmp_lg_u32 s6, 0
    s_cbranch_scc1 L_nostat_12
    v_mov_b32 v56, v54
    v_mov_b32 v57, v116
    v_mov_b32 v58, s5
    v_mov_b32 v59, s5
    v_and_b32 v60, 31, v1
    v_lshlrev_b32 v60, 4, v60
    s_mov_b32 exec_hi, 0
    buffer_store_dwordx4 v[56:59], v60, s[8:11], s21 offen sc1
    s_mov_b64 exec, -1
L_nostat_12:
    s_waitcnt lgkmcnt(10)
    v_mfma_f32_32x32x16_bf16 v[176:191], v[72:75], v[216:219], v[176:191]
    ds_read_b64_tr_b16 v[216:217], v244 offset:16384
    ds_read_b64_tr_b16 v[218:219], v245 offset:24576
    v_cvt_pk_bf16_f32 v120, v144, v160
    buffer_store_dword v120, v49, s[8:11], s24 offen offset:0 sc1
    s_waitcnt lgkmcnt(10)
    v_mfma_f32_32x32x16_bf16 v[192:207], v[72:75], v[220:223], v[192:207]
    ds_read_b64_tr_b16 v[220:221], v246 offset:16384
    ds_read_b64_tr_b16 v[222:223], v247 offset:24576
    v_cvt_pk_bf16_f32 v121, v145, v161
    buffer_store_dword v121, v49, s[8:11], s25 offen offset:0 sc1
    s_waitcnt lgkmcnt(10)
    v_mfma_f32_32x32x16_bf16 v[176:191], v[76:79], v[224:227], v[176:191]
    ds_read_b64_tr_b16 v[224:225], v244 offset:32768
    ds_read_b64_tr_b16 v[226:227], v245 offset:40960
    v_cvt_pk_bf16_f32 v122, v146, v162
    buffer_store_dword v122, v49, s[8:11], s26 offen offset:0 sc1
    s_waitcnt lgkmcnt(10)
    v_mfma_f32_32x32x16_bf16 v[192:207], v[76:79], v[228:231], v[192:207]
    ds_read_b64_tr_b16 v[228:229], v246 offset:32768
    ds_read_b64_tr_b16 v[230:231], v247 offset:40960
    v_cvt_pk_bf16_f32 v123, v147, v163
    buffer_store_dword v123, v49, s[8:11], s27 offen offset:0 sc1
    s_waitcnt lgkmcnt(10)
    v_mfma_f32_32x32x16_bf16 v[176:191], v[80:83], v[208:211], v[176:191]
    ds_read_b64_tr_b16 v[208:209], v244 offset:49152
    ds_read_b64_tr_b16 v[210:211], v245 offset:57344
    v_cvt_pk_bf16_f32 v124, v148, v164
    buffer_store_dword v124, v49, s[8:11], s28 offen offset:0 sc1
    s_waitcnt lgkmcnt(10)
    v_mfma_f32_32x32x16_bf16 v[192:207], v[80:83], v[212:215], v[192:207]
    ds_read_b64_tr_b16 v[212:213], v246 offset:49152
    ds_read_b64_tr_b16 v[214:215], v247 offset:57344
    v_cvt_pk_bf16_f32 v125, v149, v165
    buffer_store_dword v125, v49, s[8:11], s29 offen offset:0 sc1
    s_waitcnt lgkmcnt(10)
    v_mfma_f32_32x32x16_bf16 v[176:191], v[84:87], v[216:219], v[176:191]
    v_cvt_pk_bf16_f32 v126, v150, v166
    buffer_store_dword v126, v49, s[8:11], s30 offen offset:0 sc1
    s_waitcnt lgkmcnt(8)
    v_mfma_f32_32x32x16_bf16 v[192:207], v[84:87], v[220:223], v[192:207]
    v_cvt_pk_bf16_f32 v127, v151, v167
    buffer_store_dword v127, v49, s[8:11], s31 offen offset:0 sc1
    s_waitcnt lgkmcnt(6)
    v_mfma_f32_32x32x16_bf16 v[176:191], v[88:91], v[224:227], v[176:191]
    v_cvt_pk_bf16_f32 v120, v152, v168
    buffer_store_dword v120, v49, s[8:11], s32 offen offset:0 sc1
    v_cvt_pk_bf16_f32 v124, v156, v172
    buffer_store_dword v124, v49, s[8:11], s36 offen offset:0 sc1
    s_waitcnt lgkmcnt(4)
    v_mfma_f32_32x32x16_bf16 v[192:207], v[88:91], v[228:231], v[192:207]
    v_cvt_pk_bf16_f32 v121, v153, v169
    buffer_store_dword v121, v49, s[8:11], s33 offen offset:0 sc1
    v_cvt_pk_bf16_f32 v125, v157, v173
    buffer_store_dword v125, v49, s[8:11], s37 offen offset:0 sc1
    s_waitcnt lgkmcnt(2)
    v_mfma_f32_32x32x16_bf16 v[176:191], v[92:95], v[208:211], v[176:191]
    v_cvt_pk_bf16_f32 v122, v154, v170
    buffer_store_dword v122, v49, s[8:11], s34 offen offset:0 sc1
    v_cvt_pk_bf16_f32 v126, v158, v174
    buffer_store_dword v126, v49, s[8:11], s38 offen offset:0 sc1
    s_waitcnt lgkmcnt(0)
    v_mfma_f32_32x32x16_bf16 v[192:207], v[92:95], v[212:215], v[192:207]
    v_cvt_pk_bf16_f32 v123, v155, v171
    buffer_store_dword v123, v49, s[8:11], s35 offen offset:0 sc1
    v_cvt_pk_bf16_f32 v127, v159, v175
    buffer_store_dword v127, v49, s[8:11], s39 offen offset:0 sc1
    s_barrier
    s_nop 6
    v_cvt_pk_bf16_f32 v120, v176, v192
    buffer_store_dword v120, v49, s[8:11], s24 offen offset:128 sc1
    v_cvt_pk_bf16_f32 v121, v177, v193
    buffer_store_dword v121, v49, s[8:11], s25 offen offset:128 sc1
    v_cvt_pk_bf16_f32 v122, v178, v194
    buffer_store_dword v122, v49, s[8:11], s26 offen offset:128 sc1
    v_cvt_pk_bf16_f32 v123, v179, v195
    buffer_store_dword v123, v49, s[8:11], s27 offen offset:128 sc1
    v_cvt_pk_bf16_f32 v124, v180, v196
    buffer_store_dword v124, v49, s[8:11], s28 offen offset:128 sc1
    v_cvt_pk_bf16_f32 v125, v181, v197
    buffer_store_dword v125, v49, s[8:11], s29 offen offset:128 sc1
    v_cvt_pk_bf16_f32 v126, v182, v198
    buffer_store_dword v126, v49, s[8:11], s30 offen offset:128 sc1
    v_cvt_pk_bf16_f32 v127, v183, v199
    buffer_store_dword v127, v49, s[8:11], s31 offen offset:128 sc1
    v_cvt_pk_bf16_f32 v120, v184, v200
    buffer_store_dword v120, v49, s[8:11], s32 offen offset:128 sc1
    v_cvt_pk_bf16_f32 v121, v185, v201
    buffer_store_dword v121, v49, s[8:11], s33 offen offset:128 sc1
    v_cvt_pk_bf16_f32 v122, v186, v202
    buffer_store_dword v122, v49, s[8:11], s34 offen offset:128 sc1
    v_cvt_pk_bf16_f32 v123, v187, v203
    buffer_store_dword v123, v49, s[8:11], s35 offen offset:128 sc1
    v_cvt_pk_bf16_f32 v124, v188, v204
    buffer_store_dword v124, v49, s[8:11], s36 offen offset:128 sc1
    v_cvt_pk_bf16_f32 v125, v189, v205
    buffer_store_dword v125, v49, s[8:11], s37 offen offset:128 sc1
    v_cvt_pk_bf16_f32 v126, v190, v206
    buffer_store_dword v126, v49, s[8:11], s38 offen offset:128 sc1
    v_cvt_pk_bf16_f32 v127, v191, v207
    buffer_store_dword v127, v49, s[8:11], s39 offen offset:128 sc1
    s_cmp_lt_u32 s71, 43
    s_cbranch_scc1 L_FG
    s_cmp_lt_u32 s4, 8
    s_cselect_b32 s16, s12, 0
    s_cmp_eq_u32 s16, 2
    s_cbranch_scc1 L_H0
    s_endpgm
L_FG:
    v_and_b32 v8, 127, v0
    v_lshrrev_b32 v9, 2, v8
    v_lshlrev_b32 v9, 3, v9
    v_and_b32 v8, 3, v8
    v_lshl_add_u32 v8, v8, 1, v9
    v_add_u32 v8, 1, v8
    v_lshlrev_b32 v44, 7, v8
    v_lshrrev_b32 v43, 1, v1
    v_lshlrev_b32 v43, 8, v43
    v_and_b32 v9, 1, v1
    v_lshl_add_u32 v43, v9, 5, v43
    s_lshl_b32 s16, s6, 6
    v_add_u32 v43, s16, v43
    s_mov_b32 s34, 98304
    s_mov_b32 s35, 106496
    s_mov_b32 s36, 114688
    s_mov_b32 s25, 4096
    v_lshlrev_b32 v29, 4, v0
    v_lshrrev_b32 v22, 2, v1
    v_mul_u32_u24 v22, 2752, v22
    v_and_b32 v23, 3, v1
    v_lshl_add_u32 v22, v23, 4, v22
    s_mul_i32 s70, s6, 352256
    s_lshl_b32 s17, s71, 6
    s_add_u32 s70, s70, s17
    s_lshl_b32 s17, s6, 13
    s_add_u32 s42, s17, 0
    s_and_b32 s16, s6, 1
    s_lshl_b32 s16, s16, 3
    v_xor_b32 v28, s16, v1
    v_xor_b32 v24, 0, v28
    v_lshlrev_b32 v24, 4, v24
    v_xor_b32 v25, 2, v28
    v_lshlrev_b32 v25, 4, v25
    v_xor_b32 v26, 4, v28
    v_lshlrev_b32 v26, 4, v26
    v_xor_b32 v27, 6, v28
    v_lshlrev_b32 v27, 4, v27
    s_lshl_b32 s16, s71, 5
    s_lshl_b32 s17, s6, 3
    s_add_u32 s16, s16, s17
    s_lshl_b32 s37, s16, 10
    s_lshl_b32 s17, s6, 13
    s_add_u32 s43, s17, 32768
    v_lshrrev_b32 v8, 4, v1
    v_bfe_u32 v9, v1, 2, 2
    v_lshl_add_u32 v10, v8, 3, v9
    v_lshlrev_b32 v20, 6, v10
    v_and_b32 v12, 3, v1
    v_lshl_add_u32 v20, v12, 3, v20
    s_and_b32 s16, s6, 1
    s_lshl_b32 s16, s16, 5
    s_add_u32 s16, s16, 0
    v_add_u32 v20, s16, v20
    v_and_b32 v8, 1, v8
    v_lshl_or_b32 v8, v8, 2, v9
    v_lshlrev_b32 v8, 1, v8
    v_bfe_u32 v9, v1, 1, 1
    v_xor_b32 v8, v8, v9
    v_lshlrev_b32 v8, 4, v8
    v_lshl_add_u32 v21, v10, 10, v8
    v_and_b32 v9, 1, v1
    v_lshl_add_u32 v21, v9, 3, v21
    s_lshl_b32 s16, s6, 8
    s_add_u32 s16, s16, 32768
    v_add_u32 v21, s16, v21
    v_lshlrev_b32 v8, 4, v1
    s_lshl_b32 s16, s6, 10
    s_add_u32 s26, s16, 720896
    s_add_u32 s27, s26, 4096
    s_add_u32 s28, s27, 4096
    s_add_u32 s29, s28, 4096
    s_add_u32 s30, s29, 4096
    s_add_u32 s31, s30, 4096
    s_add_u32 s32, s31, 4096
    s_add_u32 s33, s32, 4096
    s_mul_i32 s16, s6, 1088
    s_add_u32 s16, s16, 131072
    v_lshl_add_u32 v10, v1, 4, s16
    v_and_b32 v11, 3, v1
    v_mul_u32_u24 v11, 1088, v11
    v_lshrrev_b32 v12, 4, v1
    v_lshl_add_u32 v11, v12, 4, v11
    v_add_u32 v11, 131072, v11
    v_and_b32 v13, 3, v1
    v_mul_u32_u24 v13, 80, v13
    v_add_u32 v13, 135424, v13
    v_lshl_add_u32 v14, v12, 4, v13
    v_lshl_add_u32 v13, v12, 3, v13
    s_and_b32 s16, s6, 1
    s_lshl_b32 s16, s16, 5
    v_add_u32 v13, s16, v13
    v_and_b32 v15, 3, v1
    v_lshlrev_b32 v15, 11, v15
    v_lshl_add_u32 v15, v12, 4, v15
    s_lshl_b32 s16, s6, 9
    v_add_u32 v15, s16, v15
    s_lshl_b32 s19, s71, 13
    s_add_u32 s19, s19, 5931008
    v_lshlrev_b32 v16, 5, v0
    s_mov_b32 s18, 6283264
    v_bfe_u32 v17, v1, 2, 2
    v_cmp_eq_u32 s[44:45], 1, v17
    v_cmp_eq_u32 s[46:47], 2, v17
    v_cmp_eq_u32 s[40:41], 3, v17
    v_lshl_add_u32 v17, v17, 6, v15
    buffer_load_dwordx4 v[132:135], v29, s[48:51], 0 offen
    buffer_load_dword v46, v44, s[8:11], s25 offen sc1
    buffer_load_dwordx4 v[140:143], v43, s[8:11], s34 offen sc1
    buffer_load_dwordx4 v[144:147], v43, s[8:11], s34 offen offset:16 sc1
    buffer_load_dwordx4 v[148:151], v43, s[8:11], s35 offen sc1
    buffer_load_dwordx4 v[152:155], v43, s[8:11], s35 offen offset:16 sc1
    buffer_load_dwordx4 v[156:159], v43, s[8:11], s36 offen sc1
    buffer_load_dwordx4 v[160:163], v43, s[8:11], s36 offen offset:16 sc1
    s_mov_b32 m0, s42
    s_nop 0
    buffer_load_dwordx4 v22, s[52:55], s70 offen  lds
    s_add_u32 s70, s70, 44032
    s_add_u32 m0, m0, 1024
    s_nop 0
    buffer_load_dwordx4 v22, s[52:55], s70 offen  lds
    s_add_u32 s70, s70, 44032
    s_add_u32 m0, m0, 1024
    s_nop 0
    buffer_load_dwordx4 v22, s[52:55], s70 offen  lds
    s_add_u32 s70, s70, 44032
    s_add_u32 m0, m0, 1024
    s_nop 0
    buffer_load_dwordx4 v22, s[52:55], s70 offen  lds
    s_add_u32 s70, s70, 44032
    s_add_u32 m0, m0, 1024
    s_nop 0
    buffer_load_dwordx4 v22, s[52:55], s70 offen  lds
    s_add_u32 s70, s70, 44032
    s_add_u32 m0, m0, 1024
    s_nop 0
    buffer_load_dwordx4 v22, s[52:55], s70 offen  lds
    s_add_u32 s70, s70, 44032
    s_add_u32 m0, m0, 1024
    s_nop 0
    buffer_load_dwordx4 v22, s[52:55], s70 offen  lds
    s_add_u32 s70, s70, 44032
    s_add_u32 m0, m0, 1024
    s_nop 0
    buffer_load_dwordx4 v22, s[52:55], s70 offen  lds
    s_mov_b32 m0, s43
    s_mov_b32 s16, s37
    buffer_load_dwordx4 v24, s[56:59], s16 offen offset:0  lds
    buffer_load_dwordx4 v25, s[56:59], s16 offen offset:1024  lds
    buffer_load_dwordx4 v26, s[56:59], s16 offen offset:2048  lds
    buffer_load_dwordx4 v27, s[56:59], s16 offen offset:3072  lds
    s_add_u32 s16, s16, 4096
    s_add_u32 m0, m0, 4096
    s_nop 0
    buffer_load_dwordx4 v24, s[56:59], s16 offen offset:0  lds
    buffer_load_dwordx4 v25, s[56:59], s16 offen offset:1024  lds
    buffer_load_dwordx4 v26, s[56:59], s16 offen offset:2048  lds
    buffer_load_dwordx4 v27, s[56:59], s16 offen offset:3072  lds
    s_waitcnt vmcnt(16)
    v_xor_b32 v12, s5, v46
    v_bitop3_b32 v12, v141, s5, v12 bitop3:0xbe
    v_bitop3_b32 v12, v143, s5, v12 bitop3:0xbe
    v_bitop3_b32 v12, v145, s5, v12 bitop3:0xbe
    v_bitop3_b32 v12, v147, s5, v12 bitop3:0xbe
    v_bitop3_b32 v12, v149, s5, v12 bitop3:0xbe
    v_bitop3_b32 v12, v151, s5, v12 bitop3:0xbe
    v_bitop3_b32 v12, v153, s5, v12 bitop3:0xbe
    v_bitop3_b32 v12, v155, s5, v12 bitop3:0xbe
    v_bitop3_b32 v12, v157, s5, v12 bitop3:0xbe
    v_bitop3_b32 v12, v159, s5, v12 bitop3:0xbe
    v_bitop3_b32 v12, v161, s5, v12 bitop3:0xbe
    v_bitop3_b32 v12, v163, s5, v12 bitop3:0xbe
    v_cmp_ne_u32 vcc, 0, v12
    s_cbranch_vccz L_fgok_14
    s_mov_b32 s7, 0
L_fgchk_13:
    s_sleep 1
    buffer_load_dword v46, v44, s[8:11], s25 offen sc1
    buffer_load_dwordx4 v[140:143], v43, s[8:11], s34 offen sc1
    buffer_load_dwordx4 v[144:147], v43, s[8:11], s34 offen offset:16 sc1
    buffer_load_dwordx4 v[148:151], v43, s[8:11], s35 offen sc1
    buffer_load_dwordx4 v[152:155], v43, s[8:11], s35 offen offset:16 sc1
    buffer_load_dwordx4 v[156:159], v43, s[8:11], s36 offen sc1
    buffer_load_dwordx4 v[160:163], v43, s[8:11], s36 offen offset:16 sc1
    s_waitcnt vmcnt(0)
    v_xor_b32 v12, s5, v46
    v_bitop3_b32 v12, v141, s5, v12 bitop3:0xbe
    v_bitop3_b32 v12, v143, s5, v12 bitop3:0xbe
    v_bitop3_b32 v12, v145, s5, v12 bitop3:0xbe
    v_bitop3_b32 v12, v147, s5, v12 bitop3:0xbe
    v_bitop3_b32 v12, v149, s5, v12 bitop3:0xbe
    v_bitop3_b32 v12, v151, s5, v12 bitop3:0xbe
    v_bitop3_b32 v12, v153, s5, v12 bitop3:0xbe
    v_bitop3_b32 v12, v155, s5, v12 bitop3:0xbe
    v_bitop3_b32 v12, v157, s5, v12 bitop3:0xbe
    v_bitop3_b32 v12, v159, s5, v12 bitop3:0xbe
    v_bitop3_b32 v12, v161, s5, v12 bitop3:0xbe
    v_bitop3_b32 v12, v163, s5, v12 bitop3:0xbe
    v_cmp_ne_u32 vcc, 0, v12
    s_cbranch_vccz L_fgok_14
    s_add_u32 s7, s7, 1
    s_cmp_lt_u32 s7, 400000
    s_cbranch_scc1 L_fgchk_13
L_fgok_14:
    v_lshlrev_b32 v48, 16, v140
    v_and_b32 v49, 0xffff0000, v140
    v_lshlrev_b32 v50, 16, v142
    v_and_b32 v51, 0xffff0000, v142
    v_lshlrev_b32 v52, 16, v144
    v_and_b32 v53, 0xffff0000, v144
    v_lshlrev_b32 v54, 16, v146
    v_and_b32 v55, 0xffff0000, v146
    v_lshlrev_b32 v56, 16, v148
    v_and_b32 v57, 0xffff0000, v148
    v_lshlrev_b32 v58, 16, v150
    v_and_b32 v59, 0xffff0000, v150
    v_lshlrev_b32 v60, 16, v152
    v_and_b32 v61, 0xffff0000, v152
    v_lshlrev_b32 v62, 16, v154
    v_and_b32 v63, 0xffff0000, v154
    v_lshlrev_b32 v64, 16, v156
    v_and_b32 v65, 0xffff0000, v156
    v_lshlrev_b32 v66, 16, v158
    v_and_b32 v67, 0xffff0000, v158
    v_lshlrev_b32 v68, 16, v160
    v_and_b32 v69, 0xffff0000, v160
    v_lshlrev_b32 v70, 16, v162
    v_and_b32 v71, 0xffff0000, v162
    v_add_f32 v64, 1.0, v64
    v_add_f32 v65, 1.0, v65
    v_add_f32 v66, 1.0, v66
    v_add_f32 v67, 1.0, v67
    v_add_f32 v68, 1.0, v68
    v_add_f32 v69, 1.0, v69
    v_add_f32 v70, 1.0, v70
    v_add_f32 v71, 1.0, v71
    v_lshlrev_b32 v72, 16, v132
    v_and_b32 v73, 0xffff0000, v132
    v_lshlrev_b32 v74, 16, v133
    v_and_b32 v75, 0xffff0000, v133
    v_lshlrev_b32 v76, 16, v134
    v_and_b32 v77, 0xffff0000, v134
    v_lshlrev_b32 v78, 16, v135
    v_and_b32 v79, 0xffff0000, v135
    s_waitcnt vmcnt(0)
    s_barrier
    ds_read_b64_tr_b16 a[0:1], v20 offset:0
    ds_read_b64_tr_b16 a[2:3], v20 offset:256
    ds_read_b64_tr_b16 a[4:5], v20 offset:2048
    ds_read_b64_tr_b16 a[6:7], v20 offset:2304
    ds_read_b64_tr_b16 a[8:9], v20 offset:4096
    ds_read_b64_tr_b16 a[10:11], v20 offset:4352
    ds_read_b64_tr_b16 a[12:13], v20 offset:6144
    ds_read_b64_tr_b16 a[14:15], v20 offset:6400
    ds_read_b64_tr_b16 a[16:17], v20 offset:8192
    ds_read_b64_tr_b16 a[18:19], v20 offset:8448
    ds_read_b64_tr_b16 a[20:21], v20 offset:10240
    ds_read_b64_tr_b16 a[22:23], v20 offset:10496
    ds_read_b64_tr_b16 a[24:25], v20 offset:12288
    ds_read_b64_tr_b16 a[26:27], v20 offset:12544
    ds_read_b64_tr_b16 a[28:29], v20 offset:14336
    ds_read_b64_tr_b16 a[30:31], v20 offset:14592
    ds_read_b64_tr_b16 a[32:33], v20 offset:16384
    ds_read_b64_tr_b16 a[34:35], v20 offset:16640
    ds_read_b64_tr_b16 a[36:37], v20 offset:18432
    ds_read_b64_tr_b16 a[38:39], v20 offset:18688
    ds_read_b64_tr_b16 a[40:41], v20 offset:20480
    ds_read_b64_tr_b16 a[42:43], v20 offset:20736
    ds_read_b64_tr_b16 a[44:45], v20 offset:22528
    ds_read_b64_tr_b16 a[46:47], v20 offset:22784
    ds_read_b64_tr_b16 a[48:49], v20 offset:24576
    ds_read_b64_tr_b16 a[50:51], v20 offset:24832
    ds_read_b64_tr_b16 a[52:53], v20 offset:26624
    ds_read_b64_tr_b16 a[54:55], v20 offset:26880
    ds_read_b64_tr_b16 a[56:57], v20 offset:28672
    ds_read_b64_tr_b16 a[58:59], v20 offset:28928
    ds_read_b64_tr_b16 a[60:61], v20 offset:30720
    ds_read_b64_tr_b16 a[62:63], v20 offset:30976
    v_xor_b32 v9, 0, v21
    ds_read_b64_tr_b16 a[64:65], v9 offset:0
    ds_read_b64_tr_b16 a[66:67], v9 offset:4096
    v_xor_b32 v9, 32, v21
    ds_read_b64_tr_b16 a[68:69], v9 offset:0
    ds_read_b64_tr_b16 a[70:71], v9 offset:4096
    v_xor_b32 v9, 64, v21
    ds_read_b64_tr_b16 a[72:73], v9 offset:0
    ds_read_b64_tr_b16 a[74:75], v9 offset:4096
    v_xor_b32 v9, 96, v21
    ds_read_b64_tr_b16 a[76:77], v9 offset:0
    ds_read_b64_tr_b16 a[78:79], v9 offset:4096
    v_xor_b32 v9, 128, v21
    ds_read_b64_tr_b16 a[80:81], v9 offset:0
    ds_read_b64_tr_b16 a[82:83], v9 offset:4096
    v_xor_b32 v9, 160, v21
    ds_read_b64_tr_b16 a[84:85], v9 offset:0
    ds_read_b64_tr_b16 a[86:87], v9 offset:4096
    v_xor_b32 v9, 192, v21
    ds_read_b64_tr_b16 a[88:89], v9 offset:0
    ds_read_b64_tr_b16 a[90:91], v9 offset:4096
    v_xor_b32 v9, 224, v21
    ds_read_b64_tr_b16 a[92:93], v9 offset:0
    ds_read_b64_tr_b16 a[94:95], v9 offset:4096
    s_waitcnt lgkmcnt(0)
    s_mov_b32 s7, 0
L_poll_15:
    buffer_load_dwordx4 v[96:99], v8, s[8:11], s26 offen sc1
    buffer_load_dwordx4 v[100:103], v8, s[8:11], s27 offen sc1
    buffer_load_dwordx4 v[104:107], v8, s[8:11], s28 offen sc1
    buffer_load_dwordx4 v[108:111], v8, s[8:11], s29 offen sc1
    buffer_load_dwordx4 v[112:115], v8, s[8:11], s30 offen sc1
    buffer_load_dwordx4 v[116:119], v8, s[8:11], s31 offen sc1
    buffer_load_dwordx4 v[120:123], v8, s[8:11], s32 offen sc1
    buffer_load_dwordx4 v[124:127], v8, s[8:11], s33 offen sc1
    s_waitcnt vmcnt(0)
    v_max3_u32 v18, v96, v97, v98
    v_max3_u32 v18, v18, v99, v100
    v_max3_u32 v18, v18, v101, v102
    v_max3_u32 v18, v18, v103, v104
    v_max3_u32 v18, v18, v105, v106
    v_max3_u32 v18, v18, v107, v108
    v_max3_u32 v18, v18, v109, v110
    v_max3_u32 v18, v18, v111, v112
    v_max3_u32 v18, v18, v113, v114
    v_max3_u32 v18, v18, v115, v116
    v_max3_u32 v18, v18, v117, v118
    v_max3_u32 v18, v18, v119, v120
    v_max3_u32 v18, v18, v121, v122
    v_max3_u32 v18, v18, v123, v124
    v_max3_u32 v18, v18, v125, v126
    v_max_u32 v18, v18, v127
    v_cmp_eq_u32 vcc, -1, v18
    s_cbranch_vccz L_pdone_16
    s_add_u32 s7, s7, 1
    s_cmp_lt_u32 s7, 400000
    s_cbranch_scc1 L_poll_15
L_pdone_16:
    s_mov_b32 s20, 0x05040100
    s_mov_b32 s21, 0x07060302
    s_mov_b32 s22, 0x3f803f80
    v_perm_b32 v20, v100, v96, s20
    v_perm_b32 v21, v100, v96, s21
    v_perm_b32 v22, v101, v97, s20
    v_perm_b32 v23, v101, v97, s21
    v_perm_b32 v24, v102, v98, s20
    v_perm_b32 v25, v102, v98, s21
    v_perm_b32 v26, v103, v99, s20
    v_perm_b32 v27, v103, v99, s21
    v_dot2_f32_bf16 v80, v20, s22, 0
    v_dot2_f32_bf16 v81, v21, s22, 0
    v_dot2_f32_bf16 v82, v22, s22, 0
    v_dot2_f32_bf16 v83, v23, s22, 0
    v_dot2_f32_bf16 v84, v24, s22, 0
    v_dot2_f32_bf16 v85, v25, s22, 0
    v_dot2_f32_bf16 v86, v26, s22, 0
    v_dot2_f32_bf16 v87, v27, s22, 0
    v_perm_b32 v20, v108, v104, s20
    v_perm_b32 v21, v108, v104, s21
    v_perm_b32 v22, v109, v105, s20
    v_perm_b32 v23, v109, v105, s21
    v_perm_b32 v24, v110, v106, s20
    v_perm_b32 v25, v110, v106, s21
    v_perm_b32 v26, v111, v107, s20
    v_perm_b32 v27, v111, v107, s21
    v_dot2_f32_bf16 v80, v20, s22, v80
    v_dot2_f32_bf16 v81, v21, s22, v81
    v_dot2_f32_bf16 v82, v22, s22, v82
    v_dot2_f32_bf16 v83, v23, s22, v83
    v_dot2_f32_bf16 v84, v24, s22, v84
    v_dot2_f32_bf16 v85, v25, s22, v85
    v_dot2_f32_bf16 v86, v26, s22, v86
    v_dot2_f32_bf16 v87, v27, s22, v87
    v_perm_b32 v20, v116, v112, s20
    v_perm_b32 v21, v116, v112, s21
    v_perm_b32 v22, v117, v113, s20
    v_perm_b32 v23, v117, v113, s21
    v_perm_b32 v24, v118, v114, s20
    v_perm_b32 v25, v118, v114, s21
    v_perm_b32 v26, v119, v115, s20
    v_perm_b32 v27, v119, v115, s21
    v_dot2_f32_bf16 v80, v20, s22, v80
    v_dot2_f32_bf16 v81, v21, s22, v81
    v_dot2_f32_bf16 v82, v22, s22, v82
    v_dot2_f32_bf16 v83, v23, s22, v83
    v_dot2_f32_bf16 v84, v24, s22, v84
    v_dot2_f32_bf16 v85, v25, s22, v85
    v_dot2_f32_bf16 v86, v26, s22, v86
    v_dot2_f32_bf16 v87, v27, s22, v87
    v_perm_b32 v20, v124, v120, s20
    v_perm_b32 v21, v124, v120, s21
    v_perm_b32 v22, v125, v121, s20
    v_perm_b32 v23, v125, v121, s21
    v_perm_b32 v24, v126, v122, s20
    v_perm_b32 v25, v126, v122, s21
    v_perm_b32 v26, v127, v123, s20
    v_perm_b32 v27, v127, v123, s21
    v_dot2_f32_bf16 v80, v20, s22, v80
    v_dot2_f32_bf16 v81, v21, s22, v81
    v_dot2_f32_bf16 v82, v22, s22, v82
    v_dot2_f32_bf16 v83, v23, s22, v83
    v_dot2_f32_bf16 v84, v24, s22, v84
    v_dot2_f32_bf16 v85, v25, s22, v85
    v_dot2_f32_bf16 v86, v26, s22, v86
    v_dot2_f32_bf16 v87, v27, s22, v87
    v_pk_fma_f32 v[72:73], v[48:49], v[80:81], v[72:73]
    v_pk_fma_f32 v[74:75], v[50:51], v[82:83], v[74:75]
    v_pk_fma_f32 v[76:77], v[52:53], v[84:85], v[76:77]
    v_pk_fma_f32 v[78:79], v[54:55], v[86:87], v[78:79]
    s_cmp_lg_u32 s71, 0
    s_cbranch_scc1 L_nox1_17
    buffer_store_dwordx4 v[72:75], v16, s[8:11], s18 offen sc1
    buffer_store_dwordx4 v[76:79], v16, s[8:11], s18 offen offset:16 sc1
L_nox1_17:
    v_pk_add_f32 v[80:81], v[72:73], v[74:75]
    v_pk_mul_f32 v[82:83], v[72:73], v[72:73]
    v_pk_add_f32 v[84:85], v[76:77], v[78:79]
    v_pk_fma_f32 v[82:83], v[74:75], v[74:75], v[82:83]
    v_pk_add_f32 v[80:81], v[80:81], v[84:85]
    v_pk_fma_f32 v[82:83], v[76:77], v[76:77], v[82:83]
    v_pk_fma_f32 v[82:83], v[78:79], v[78:79], v[82:83]
    v_add_f32 v80, v80, v81
    v_add_f32 v81, v82, v83
    s_nop 0
    v_add_f32_dpp v80, v80, v80 row_ror:8 row_mask:0xf bank_mask:0xf
    v_add_f32_dpp v81, v81, v81 row_ror:8 row_mask:0xf bank_mask:0xf
    s_nop 0
    v_add_f32_dpp v80, v80, v80 row_ror:4 row_mask:0xf bank_mask:0xf
    v_add_f32_dpp v81, v81, v81 row_ror:4 row_mask:0xf bank_mask:0xf
    s_nop 0
    v_add_f32_dpp v80, v80, v80 row_ror:2 row_mask:0xf bank_mask:0xf
    v_add_f32_dpp v81, v81, v81 row_ror:2 row_mask:0xf bank_mask:0xf
    s_nop 0
    v_add_f32_dpp v80, v80, v80 row_ror:1 row_mask:0xf bank_mask:0xf
    v_add_f32_dpp v81, v81, v81 row_ror:1 row_mask:0xf bank_mask:0xf
    v_mov_b32 v82, v80
    v_mov_b32 v83, v81
    s_nop 0
    v_permlane16_swap_b32 v80, v82
    v_permlane16_swap_b32 v81, v83
    v_add_f32 v80, v80, v82
    v_add_f32 v81, v81, v83
    v_mov_b32 v82, v80
    v_mov_b32 v83, v81
    s_nop 0
    v_permlane32_swap_b32 v80, v82
    v_permlane32_swap_b32 v81, v83
    v_add_f32 v80, v80, v82
    v_add_f32 v81, v81, v83
    v_mul_f32 v80, 989855744, v80
    v_mul_f32 v81, 989855744, v81
    v_fma_f32 v81, -v80, v80, v81
    v_add_f32 v81, 925353388, v81
    v_rsq_f32 v82, v81
    v_mov_b32 v81, v80
    v_mov_b32 v83, v82
    v_pk_add_f32 v[88:89], v[72:73], v[80:81] neg_lo:[0,1] neg_hi:[0,1]
    v_pk_add_f32 v[90:91], v[74:75], v[80:81] neg_lo:[0,1] neg_hi:[0,1]
    v_pk_add_f32 v[92:93], v[76:77], v[80:81] neg_lo:[0,1] neg_hi:[0,1]
    v_pk_add_f32 v[94:95], v[78:79], v[80:81] neg_lo:[0,1] neg_hi:[0,1]
    v_pk_mul_f32 v[64:65], v[64:65], v[82:83]
    v_pk_mul_f32 v[66:67], v[66:67], v[82:83]
    v_pk_mul_f32 v[68:69], v[68:69], v[82:83]
    v_pk_mul_f32 v[70:71], v[70:71], v[82:83]
    v_pk_fma_f32 v[56:57], v[88:89], v[64:65], v[56:57]
    v_pk_fma_f32 v[58:59], v[90:91], v[66:67], v[58:59]
    v_pk_fma_f32 v[60:61], v[92:93], v[68:69], v[60:61]
    v_pk_fma_f32 v[62:63], v[94:95], v[70:71], v[62:63]
    v_cvt_pk_bf16_f32 v88, v56, v57
    v_cvt_pk_bf16_f32 v89, v58, v59
    v_cvt_pk_bf16_f32 v90, v60, v61
    v_cvt_pk_bf16_f32 v91, v62, v63
    ds_write_b128 v10, v[88:91]
    s_waitcnt lgkmcnt(0)
    s_barrier
    s_cmp_ge_u32 s6, 2
    s_cbranch_scc1 L_now1_18
    ds_read_b128 v[96:99], v11 offset:0
    ds_read_b128 v[100:103], v11 offset:64
    ds_read_b128 v[104:107], v11 offset:128
    ds_read_b128 v[108:111], v11 offset:192
    ds_read_b128 v[112:115], v11 offset:256
    ds_read_b128 v[116:119], v11 offset:320
    ds_read_b128 v[120:123], v11 offset:384
    ds_read_b128 v[124:127], v11 offset:448
    ds_read_b128 v[128:131], v11 offset:512
    ds_read_b128 v[132:135], v11 offset:576
    ds_read_b128 v[136:139], v11 offset:640
    ds_read_b128 v[140:143], v11 offset:704
    ds_read_b128 v[144:147], v11 offset:768
    ds_read_b128 v[148:151], v11 offset:832
    ds_read_b128 v[152:155], v11 offset:896
    ds_read_b128 v[156:159], v11 offset:960
    s_waitcnt lgkmcnt(15)
    v_mfma_f32_16x16x32_bf16 v[20:23], a[0:3], v[96:99], 0
    s_waitcnt lgkmcnt(14)
    v_mfma_f32_16x16x32_bf16 v[24:27], a[4:7], v[100:103], 0
    s_waitcnt lgkmcnt(13)
    v_mfma_f32_16x16x32_bf16 v[20:23], a[8:11], v[104:107], v[20:23]
    s_waitcnt lgkmcnt(12)
    v_mfma_f32_16x16x32_bf16 v[24:27], a[12:15], v[108:111], v[24:27]
    s_waitcnt lgkmcnt(11)
    v_mfma_f32_16x16x32_bf16 v[20:23], a[16:19], v[112:115], v[20:23]
    s_waitcnt lgkmcnt(10)
    v_mfma_f32_16x16x32_bf16 v[24:27], a[20:23], v[116:119], v[24:27]
    s_waitcnt lgkmcnt(9)
    v_mfma_f32_16x16x32_bf16 v[20:23], a[24:27], v[120:123], v[20:23]
    s_waitcnt lgkmcnt(8)
    v_mfma_f32_16x16x32_bf16 v[24:27], a[28:31], v[124:127], v[24:27]
    s_waitcnt lgkmcnt(7)
    v_mfma_f32_16x16x32_bf16 v[20:23], a[32:35], v[128:131], v[20:23]
    s_waitcnt lgkmcnt(6)
    v_mfma_f32_16x16x32_bf16 v[24:27], a[36:39], v[132:135], v[24:27]
    s_waitcnt lgkmcnt(5)
    v_mfma_f32_16x16x32_bf16 v[20:23], a[40:43], v[136:139], v[20:23]
    s_waitcnt lgkmcnt(4)
    v_mfma_f32_16x16x32_bf16 v[24:27], a[44:47], v[140:143], v[24:27]
    s_waitcnt lgkmcnt(3)
    v_mfma_f32_16x16x32_bf16 v[20:23], a[48:51], v[144:147], v[20:23]
    s_waitcnt lgkmcnt(2)
    v_mfma_f32_16x16x32_bf16 v[24:27], a[52:55], v[148:151], v[24:27]
    s_waitcnt lgkmcnt(1)
    v_mfma_f32_16x16x32_bf16 v[20:23], a[56:59], v[152:155], v[20:23]
    s_waitcnt lgkmcnt(0)
    v_mfma_f32_16x16x32_bf16 v[24:27], a[60:63], v[156:159], v[24:27]
    s_nop 7
    v_pk_add_f32 v[20:21], v[20:21], v[24:25]
    v_pk_add_f32 v[22:23], v[22:23], v[26:27]
    v_max_f32 v20, 0, v20
    v_max_f32 v21, 0, v21
    v_max_f32 v22, 0, v22
    v_max_f32 v23, 0, v23
    v_cvt_pk_bf16_f32 v24, v20, v21
    v_cvt_pk_bf16_f32 v25, v22, v23
    s_mov_b32 exec_lo, 0x000F000F
    s_mov_b32 exec_hi, 0x000F000F
    ds_write_b64 v13, v[24:25]
    s_mov_b64 exec, -1
L_now1_18:
    s_waitcnt lgkmcnt(0)
    s_barrier
    ds_read_b128 v[24:27], v14
    s_waitcnt lgkmcnt(0)
    v_mfma_f32_16x16x32_bf16 v[32:35], a[64:67], v[24:27], 0
    v_mfma_f32_16x16x32_bf16 v[36:39], a[68:71], v[24:27], 0
    v_mfma_f32_16x16x32_bf16 v[40:43], a[72:75], v[24:27], 0
    v_mfma_f32_16x16x32_bf16 v[44:47], a[76:79], v[24:27], 0
    v_mfma_f32_16x16x32_bf16 v[48:51], a[80:83], v[24:27], 0
    v_mfma_f32_16x16x32_bf16 v[52:55], a[84:87], v[24:27], 0
    v_mfma_f32_16x16x32_bf16 v[56:59], a[88:91], v[24:27], 0
    v_mfma_f32_16x16x32_bf16 v[60:63], a[92:95], v[24:27], 0
    s_nop 1
    v_cndmask_b32 v64, v32, v36, s[44:45]
    v_cndmask_b32 v65, v33, v37, s[44:45]
    v_cndmask_b32 v66, v34, v38, s[44:45]
    v_cndmask_b32 v67, v35, v39, s[44:45]
    v_cndmask_b32 v64, v64, v40, s[46:47]
    v_cndmask_b32 v65, v65, v41, s[46:47]
    v_cndmask_b32 v66, v66, v42, s[46:47]
    v_cndmask_b32 v67, v67, v43, s[46:47]
    v_cndmask_b32 v64, v64, v44, s[40:41]
    v_cndmask_b32 v65, v65, v45, s[40:41]
    v_cndmask_b32 v66, v66, v46, s[40:41]
    v_cndmask_b32 v67, v67, v47, s[40:41]
    buffer_store_dwordx4 v[64:67], v17, s[8:11], s19 offen offset:0 sc1
    v_cndmask_b32 v68, v48, v52, s[44:45]
    v_cndmask_b32 v69, v49, v53, s[44:45]
    v_cndmask_b32 v70, v50, v54, s[44:45]
    v_cndmask_b32 v71, v51, v55, s[44:45]
    v_cndmask_b32 v68, v68, v56, s[46:47]
    v_cndmask_b32 v69, v69, v57, s[46:47]
    v_cndmask_b32 v70, v70, v58, s[46:47]
    v_cndmask_b32 v71, v71, v59, s[46:47]
    v_cndmask_b32 v68, v68, v60, s[40:41]
    v_cndmask_b32 v69, v69, v61, s[40:41]
    v_cndmask_b32 v70, v70, v62, s[40:41]
    v_cndmask_b32 v71, v71, v63, s[40:41]
    buffer_store_dwordx4 v[68:71], v17, s[8:11], s19 offen offset:256 sc1
    s_endpgm
L_H0:
    v_min_u32 v8, 42, v1
    v_subrev_u32 v9, 22, v8
    v_lshlrev_b32 v9, 3, v9
    v_add_u32 v9, 2, v9
    v_lshlrev_b32 v10, 3, v8
    v_cmp_gt_u32 vcc, 22, v8
    s_nop 1
    v_cndmask_b32 v8, v9, v10, vcc
    v_lshlrev_b32 v44, 7, v8
    s_and_b32 s23, s4, 1
    s_lshr_b32 s22, s4, 1
    s_lshl_b32 s23, s23, 2
    s_add_u32 s23, s23, s6
    v_bfe_u32 v8, v1, 2, 2
    v_lshlrev_b32 v8, 8, v8
    v_and_b32 v9, 3, v1
    v_lshl_add_u32 v45, v9, 4, v8
    s_lshl_b32 s24, s23, 10
    s_lshl_b32 s17, s22, 6
    s_add_u32 s24, s24, s17
    s_add_u32 s24, s24, 122880
    s_mov_b32 s25, 4096
    s_mov_b32 s7, 0
L_poll_19:
    buffer_load_dword v46, v44, s[8:11], s25 offen sc1
    buffer_load_dwordx4 v[136:139], v45, s[8:11], s24 offen sc1
    s_waitcnt vmcnt(0)
    v_xor_b32 v12, s5, v46
    v_bitop3_b32 v12, v137, s5, v12 bitop3:0xbe
    v_bitop3_b32 v12, v139, s5, v12 bitop3:0xbe
    v_cmp_ne_u32 vcc, 0, v12
    s_cbranch_vccz L_pdone_20
    s_sleep 2
    s_add_u32 s7, s7, 1
    s_cmp_lt_u32 s7, 400000
    s_cbranch_scc1 L_poll_19
L_pdone_20:
    v_lshlrev_b32 v64, 16, v136
    v_and_b32 v65, 0xffff0000, v136
    v_lshlrev_b32 v66, 16, v138
    v_and_b32 v67, 0xffff0000, v138
    v_lshrrev_b32 v9, 4, v1
    v_cmp_eq_u32 vcc, 3, v9
    s_nop 1
    v_cndmask_b32 v68, v64, 1.0, vcc
    v_cndmask_b32 v69, v65, 1.0, vcc
    v_cndmask_b32 v70, v66, 1.0, vcc
    v_cndmask_b32 v71, v67, 1.0, vcc
    s_lshl_b32 s16, s22, 11
    s_lshl_b32 s17, s23, 8
    s_add_u32 s16, s16, s17
    s_add_u32 s24, s16, 5931008
    v_and_b32 v8, 15, v1
    v_lshlrev_b32 v8, 4, v8
    v_lshrrev_b32 v9, 4, v1
    v_lshl_add_u32 v8, v9, 13, v8
    s_mov_b32 s7, 0
L_poll_22:
    s_mov_b32 s16, s24
    buffer_load_dwordx4 v[16:19], v8, s[8:11], s16 offen sc1
    s_add_u32 s16, s16, 32768
    buffer_load_dwordx4 v[20:23], v8, s[8:11], s16 offen sc1
    s_add_u32 s16, s16, 32768
    buffer_load_dwordx4 v[24:27], v8, s[8:11], s16 offen sc1
    s_add_u32 s16, s16, 32768
    buffer_load_dwordx4 v[28:31], v8, s[8:11], s16 offen sc1
    s_add_u32 s16, s16, 32768
    buffer_load_dwordx4 v[32:35], v8, s[8:11], s16 offen sc1
    s_add_u32 s16, s16, 32768
    buffer_load_dwordx4 v[36:39], v8, s[8:11], s16 offen sc1
    s_add_u32 s16, s16, 32768
    buffer_load_dwordx4 v[40:43], v8, s[8:11], s16 offen sc1
    s_add_u32 s16, s16, 32768
    buffer_load_dwordx4 v[44:47], v8, s[8:11], s16 offen sc1
    s_add_u32 s16, s16, 32768
    buffer_load_dwordx4 v[48:51], v8, s[8:11], s16 offen sc1
    s_add_u32 s16, s16, 32768
    buffer_load_dwordx4 v[52:55], v8, s[8:11], s16 offen sc1
    s_add_u32 s16, s16, 32768
    buffer_load_dwordx4 v[56:59], v8, s[8:11], s16 offen sc1
    s_waitcnt vmcnt(0)
    v_max3_u32 v9, v16, v17, v18
    v_max3_u32 v9, v9, v19, v20
    v_max3_u32 v9, v9, v21, v22
    v_max3_u32 v9, v9, v23, v24
    v_max3_u32 v9, v9, v25, v26
    v_max3_u32 v9, v9, v27, v28
    v_max3_u32 v9, v9, v29, v30
    v_max3_u32 v9, v9, v31, v32
    v_max3_u32 v9, v9, v33, v34
    v_max3_u32 v9, v9, v35, v36
    v_max3_u32 v9, v9, v37, v38
    v_max3_u32 v9, v9, v39, v40
    v_max3_u32 v9, v9, v41, v42
    v_max3_u32 v9, v9, v43, v44
    v_max3_u32 v9, v9, v45, v46
    v_max3_u32 v9, v9, v47, v48
    v_max3_u32 v9, v9, v49, v50
    v_max3_u32 v9, v9, v51, v52
    v_max3_u32 v9, v9, v53, v54
    v_max3_u32 v9, v9, v55, v56
    v_max3_u32 v9, v9, v57, v58
    v_max_u32 v9, v9, v59
    v_cmp_eq_u32 vcc, -1, v9
    s_cbranch_vccz L_pdone_23
    s_add_u32 s7, s7, 1
    s_cmp_lt_u32 s7, 400000
    s_cbranch_scc1 L_poll_22
L_pdone_23:
    v_pk_add_f32 v[16:17], v[16:17], v[20:21]
    v_pk_add_f32 v[18:19], v[18:19], v[22:23]
    v_pk_add_f32 v[24:25], v[24:25], v[28:29]
    v_pk_add_f32 v[26:27], v[26:27], v[30:31]
    v_pk_add_f32 v[32:33], v[32:33], v[36:37]
    v_pk_add_f32 v[34:35], v[34:35], v[38:39]
    v_pk_add_f32 v[40:41], v[40:41], v[44:45]
    v_pk_add_f32 v[42:43], v[42:43], v[46:47]
    v_pk_add_f32 v[48:49], v[48:49], v[52:53]
    v_pk_add_f32 v[50:51], v[50:51], v[54:55]
    v_pk_mul_f32 v[60:61], v[56:57], v[68:69]
    v_pk_mul_f32 v[62:63], v[58:59], v[70:71]
    v_pk_add_f32 v[16:17], v[16:17], v[24:25]
    v_pk_add_f32 v[18:19], v[18:19], v[26:27]
    v_pk_add_f32 v[32:33], v[32:33], v[40:41]
    v_pk_add_f32 v[34:35], v[34:35], v[42:43]
    v_pk_add_f32 v[16:17], v[16:17], v[32:33]
    v_pk_add_f32 v[18:19], v[18:19], v[34:35]
    v_pk_add_f32 v[16:17], v[16:17], v[48:49]
    v_pk_add_f32 v[18:19], v[18:19], v[50:51]
    v_pk_fma_f32 v[60:61], v[16:17], v[64:65], v[60:61]
    v_pk_fma_f32 v[62:63], v[18:19], v[66:67], v[62:63]
    v_mov_b32 v20, v60
    v_mov_b32 v21, v61
    v_mov_b32 v22, v62
    v_mov_b32 v23, v63
    v_permlane16_swap_b32 v60, v20
    v_permlane16_swap_b32 v61, v21
    v_permlane16_swap_b32 v62, v22
    v_permlane16_swap_b32 v63, v23
    v_add_f32 v60, v60, v20
    v_add_f32 v61, v61, v21
    v_add_f32 v62, v62, v22
    v_add_f32 v63, v63, v23
    v_mov_b32 v20, v60
    v_mov_b32 v21, v61
    v_mov_b32 v22, v62
    v_mov_b32 v23, v63
    v_permlane32_swap_b32 v60, v20
    v_permlane32_swap_b32 v61, v21
    v_permlane32_swap_b32 v62, v22
    v_permlane32_swap_b32 v63, v23
    v_add_f32 v60, v60, v20
    v_add_f32 v61, v61, v21
    v_add_f32 v62, v62, v22
    v_add_f32 v63, v63, v23
    v_cvt_pk_bf16_f32 v38, v60, v61
    v_cvt_pk_bf16_f32 v39, v62, v63
    s_lshl_b32 s16, s22, 10
    s_lshl_b32 s17, s23, 7
    s_add_u32 s16, s16, s17
    v_and_b32 v9, 15, v1
    v_lshlrev_b32 v9, 3, v9
    s_mov_b32 exec_lo, 0xffff
    s_mov_b32 exec_hi, 0
    buffer_store_dwordx2 v[38:39], v9, s[60:63], s16 offen
    s_mov_b64 exec, -1
    s_cmp_lg_u32 s4, 0
    s_cbranch_scc1 L_noep_24
    s_cmp_lg_u32 s6, 0
    s_cbranch_scc1 L_noep_24
    v_mov_b32 v10, s5
    s_mov_b32 exec_lo, 1
    s_mov_b32 exec_hi, 0
    buffer_store_dword v10, v3, s[8:11], 0 offen sc1
    s_mov_b64 exec, -1
L_noep_24:
    s_endpgm
L_W:
    s_load_dwordx2 s[48:49], s[0:1], 0
    s_load_dwordx2 s[56:57], s[0:1], 16
    s_load_dwordx2 s[60:61], s[0:1], 24
    s_load_dwordx2 s[40:41], s[0:1], 72
    s_load_dwordx2 s[44:45], s[0:1], 80
    s_load_dwordx2 s[64:65], s[0:1], 32
    s_load_dwordx2 s[68:69], s[0:1], 40
    s_lshl_b32 s14, s12, 3
    s_lshr_b32 s16, s4, 2
    s_add_u32 s14, s14, s16
    s_and_b32 s15, s4, 3
    s_mov_b32 s50, 4096
    s_mov_b32 s51, 0x00020000
    s_mov_b32 s58, 4194304
    s_mov_b32 s59, 0x00020000
    s_mov_b32 s62, 4194304
    s_mov_b32 s63, 0x00020000
    s_mov_b32 s42, 4096
    s_mov_b32 s43, 0x00020000
    s_mov_b32 s46, 3145728
    s_mov_b32 s47, 0x00020000
    s_mov_b32 s66, 4194304
    s_mov_b32 s67, 0x00020000
    s_mov_b32 s70, 4194304
    s_mov_b32 s71, 0x00020000
    s_lshl_b32 s29, s15, 2
    s_add_u32 s29, s29, s6
    s_lshl_b32 s29, s29, 18
    s_lshl_b32 s17, s14, 8
    s_add_u32 s29, s29, s17
    v_lshlrev_b32 v5, 4, v0
    s_waitcnt lgkmcnt(0)
    buffer_load_dword v4, v3, s[8:11], 0 offen sc1
    buffer_load_dwordx4 v[12:15], v5, s[48:51], 0 offen
    v_lshrrev_b32 v20, 4, v1
    v_and_b32 v21, 15, v1
    v_lshlrev_b32 v22, 1, v20
    v_xor_b32 v23, v21, v22
    v_xor_b32 v24, 8, v23
    v_lshlrev_b32 v20, 13, v20
    v_lshl_add_u32 v23, v23, 4, v20
    v_lshl_add_u32 v24, v24, 4, v20
    s_lshl_b32 s17, s6, 13
    s_add_u32 m0, s17, 0
    s_mov_b32 s16, s29
    buffer_load_dwordx4 v23, s[56:59], s16 offen  lds
    s_add_u32 s16, s16, 32768
    s_add_u32 m0, m0, 1024
    s_nop 0
    buffer_load_dwordx4 v23, s[56:59], s16 offen  lds
    s_add_u32 s16, s16, 32768
    s_add_u32 m0, m0, 1024
    s_nop 0
    buffer_load_dwordx4 v24, s[56:59], s16 offen  lds
    s_add_u32 s16, s16, 32768
    s_add_u32 m0, m0, 1024
    s_nop 0
    buffer_load_dwordx4 v24, s[56:59], s16 offen  lds
    s_add_u32 s16, s16, 32768
    s_add_u32 m0, m0, 1024
    s_nop 0
    buffer_load_dwordx4 v23, s[56:59], s16 offen  lds
    s_add_u32 s16, s16, 32768
    s_add_u32 m0, m0, 1024
    s_nop 0
    buffer_load_dwordx4 v23, s[56:59], s16 offen  lds
    s_add_u32 s16, s16, 32768
    s_add_u32 m0, m0, 1024
    s_nop 0
    buffer_load_dwordx4 v24, s[56:59], s16 offen  lds
    s_add_u32 s16, s16, 32768
    s_add_u32 m0, m0, 1024
    s_nop 0
    buffer_load_dwordx4 v24, s[56:59], s16 offen  lds
    v_lshrrev_b32 v20, 4, v1
    v_and_b32 v21, 15, v1
    v_lshlrev_b32 v22, 1, v20
    v_xor_b32 v23, v21, v22
    v_xor_b32 v24, 8, v23
    v_lshlrev_b32 v20, 13, v20
    v_lshl_add_u32 v23, v23, 4, v20
    v_lshl_add_u32 v24, v24, 4, v20
    s_lshl_b32 s17, s6, 13
    s_add_u32 m0, s17, 32768
    s_mov_b32 s16, s29
    buffer_load_dwordx4 v23, s[60:63], s16 offen  lds
    s_add_u32 s16, s16, 32768
    s_add_u32 m0, m0, 1024
    s_nop 0
    buffer_load_dwordx4 v23, s[60:63], s16 offen  lds
    s_add_u32 s16, s16, 32768
    s_add_u32 m0, m0, 1024
    s_nop 0
    buffer_load_dwordx4 v24, s[60:63], s16 offen  lds
    s_add_u32 s16, s16, 32768
    s_add_u32 m0, m0, 1024
    s_nop 0
    buffer_load_dwordx4 v24, s[60:63], s16 offen  lds
    s_add_u32 s16, s16, 32768
    s_add_u32 m0, m0, 1024
    s_nop 0
    buffer_load_dwordx4 v23, s[60:63], s16 offen  lds
    s_add_u32 s16, s16, 32768
    s_add_u32 m0, m0, 1024
    s_nop 0
    buffer_load_dwordx4 v23, s[60:63], s16 offen  lds
    s_add_u32 s16, s16, 32768
    s_add_u32 m0, m0, 1024
    s_nop 0
    buffer_load_dwordx4 v24, s[60:63], s16 offen  lds
    s_add_u32 s16, s16, 32768
    s_add_u32 m0, m0, 1024
    s_nop 0
    buffer_load_dwordx4 v24, s[60:63], s16 offen  lds
    v_mov_b32 v16, -1
    v_mov_b32 v17, -1
    v_mov_b32 v18, -1
    v_mov_b32 v19, -1
    v_lshrrev_b32 v20, 4, v1
    v_and_b32 v21, 15, v1
    s_cmp_eq_u32 s6, 0
    s_cbranch_scc0 L_c1_25
    v_lshlrev_b32 v25, 15, v20
    v_lshl_add_u32 v25, v21, 4, v25
    s_lshl_b32 s16, s14, 10
    s_lshl_b32 s17, s15, 8
    s_add_u32 s16, s16, s17
    s_add_u32 s16, s16, 393216
    s_branch L_ce_27
L_c1_25:
    s_cmp_eq_u32 s6, 2
    s_cbranch_scc0 L_c5_26
    s_bitcmp1_b32 s4, 0
    s_cbranch_scc1 L_c5_26
    v_bfe_u32 v20, v1, 3, 2
    v_lshlrev_b32 v25, 10, v20
    v_and_b32 v21, 7, v1
    v_lshl_add_u32 v25, v21, 4, v25
    s_lshl_b32 s16, s12, 1
    s_lshr_b32 s17, s4, 4
    s_add_u32 s16, s16, s17
    s_lshl_b32 s16, s16, 12
    s_bfe_u32 s17, s4, 0x30001
    s_lshl_b32 s17, s17, 7
    s_add_u32 s16, s16, s17
    s_add_u32 s16, s16, 720896
    s_branch L_ce_27
L_c5_26:
    v_lshlrev_b32 v25, 10, v20
    v_lshl_add_u32 v25, v21, 4, v25
    s_lshl_b32 s16, s14, 12
    s_lshl_b32 s17, s15, 8
    s_add_u32 s16, s16, s17
    s_add_u32 s16, s16, 589824
L_ce_27:
    buffer_store_dwordx4 v[16:19], v25, s[8:11], s16 offen sc1
    s_waitcnt vmcnt(17)
    v_readfirstlane_b32 s5, v4
    s_mul_i32 s5, s5, 2654435761
    s_add_u32 s5, s5, 2135587861
    s_cmp_lg_u32 s6, 3
    s_cbranch_scc1 L_noxid_28
    s_getreg_b32 s53, hwreg(HW_REG_XCC_ID, 0, 4)
    s_lshl_b32 s16, s2, 6
    s_add_u32 s16, s16, 36864
    v_mov_b32 v30, s5
    v_mov_b32 v31, s53
    s_mov_b32 exec_lo, 1
    s_mov_b32 exec_hi, 0
    buffer_store_dwordx2 v[30:31], v3, s[8:11], s16 offen sc1
    s_mov_b64 exec, -1
L_noxid_28:
    v_lshlrev_b32 v24, 16, v12
    v_and_b32 v25, 0xffff0000, v12
    v_lshlrev_b32 v26, 16, v13
    v_and_b32 v27, 0xffff0000, v13
    v_lshlrev_b32 v28, 16, v14
    v_and_b32 v29, 0xffff0000, v14
    v_lshlrev_b32 v30, 16, v15
    v_and_b32 v31, 0xffff0000, v15
    v_pk_add_f32 v[32:33], v[24:25], v[26:27]
    v_pk_add_f32 v[34:35], v[28:29], v[30:31]
    v_pk_add_f32 v[32:33], v[32:33], v[34:35]
    v_add_f32 v32, v32, v33
    s_nop 1
    v_add_f32_dpp v32, v32, v32 row_ror:8 row_mask:0xf bank_mask:0xf
    s_nop 1
    v_add_f32_dpp v32, v32, v32 row_ror:4 row_mask:0xf bank_mask:0xf
    s_nop 1
    v_add_f32_dpp v32, v32, v32 row_ror:2 row_mask:0xf bank_mask:0xf
    s_nop 1
    v_add_f32_dpp v32, v32, v32 row_ror:1 row_mask:0xf bank_mask:0xf
    v_mov_b32 v33, v32
    s_nop 1
    v_permlane16_swap_b32 v32, v33
    v_add_f32 v32, v32, v33
    v_mov_b32 v33, v32
    s_nop 1
    v_permlane32_swap_b32 v32, v33
    v_add_f32 v32, v32, v33
    v_mul_f32 v32, 989855744, v32
    v_sub_f32 v24, v24, v32
    v_sub_f32 v25, v25, v32
    v_sub_f32 v26, v26, v32
    v_sub_f32 v27, v27, v32
    v_sub_f32 v28, v28, v32
    v_sub_f32 v29, v29, v32
    v_sub_f32 v30, v30, v32
    v_sub_f32 v31, v31, v32
    v_mul_f32 v33, v24, v24
    v_fmac_f32 v33, v25, v25
    v_fmac_f32 v33, v26, v26
    v_fmac_f32 v33, v27, v27
    v_fmac_f32 v33, v28, v28
    v_fmac_f32 v33, v29, v29
    v_fmac_f32 v33, v30, v30
    v_fmac_f32 v33, v31, v31
    s_nop 1
    v_add_f32_dpp v33, v33, v33 row_ror:8 row_mask:0xf bank_mask:0xf
    s_nop 1
    v_add_f32_dpp v33, v33, v33 row_ror:4 row_mask:0xf bank_mask:0xf
    s_nop 1
    v_add_f32_dpp v33, v33, v33 row_ror:2 row_mask:0xf bank_mask:0xf
    s_nop 1
    v_add_f32_dpp v33, v33, v33 row_ror:1 row_mask:0xf bank_mask:0xf
    v_mov_b32 v34, v33
    s_nop 1
    v_permlane16_swap_b32 v33, v34
    v_add_f32 v33, v33, v34
    v_mov_b32 v34, v33
    s_nop 1
    v_permlane32_swap_b32 v33, v34
    v_add_f32 v33, v33, v34
    v_mov_b32 v34, 925353388
    v_fmac_f32 v34, 989855744, v33
    v_rsq_f32 v34, v34
    s_nop 0
    v_mul_f32 v24, v24, v34
    v_mul_f32 v25, v25, v34
    v_mul_f32 v26, v26, v34
    v_mul_f32 v27, v27, v34
    v_mul_f32 v28, v28, v34
    v_mul_f32 v29, v29, v34
    v_mul_f32 v30, v30, v34
    v_mul_f32 v31, v31, v34
    s_lshl_b32 s16, s6, 11
    s_add_u32 s16, s16, 131072
    v_lshl_add_u32 v20, v1, 5, s16
    ds_write_b128 v20, v[24:27]
    ds_write_b128 v20, v[28:31] offset:16
    v_lshrrev_b32 v230, 4, v1
    v_and_b32 v231, 3, v1
    v_mul_u32_u24 v224, 320, v231
    v_lshl_add_u32 v224, v230, 4, v224
    v_add_u32 v224, 139264, v224
    v_lshlrev_b32 v225, 6, v231
    v_lshl_add_u32 v225, v230, 4, v225
    s_lshl_b32 s19, s14, 13
    s_lshl_b32 s16, s6, 11
    s_add_u32 s19, s19, s16
    s_lshl_b32 s16, s15, 8
    s_add_u32 s19, s19, s16
    s_add_u32 s19, s19, 131072
    v_and_b32 v226, 15, v1
    v_lshlrev_b32 v226, 6, v226
    v_lshl_add_u32 v226, v230, 4, v226
    s_lshl_b32 s20, s14, 13
    s_add_u32 s20, s20, 131072
    s_add_u32 s28, s20, 4096
    v_lshlrev_b32 v227, 15, v231
    v_lshl_add_u32 v227, v230, 4, v227
    s_lshl_b32 s16, s6, 6
    v_add_u32 v227, s16, v227
    s_lshl_b32 s21, s14, 10
    s_lshl_b32 s16, s15, 8
    s_add_u32 s21, s21, s16
    s_add_u32 s21, s21, 393216
    v_bfe_u32 v232, v1, 2, 2
    v_lshl_add_u32 v228, v232, 3, v231
    v_lshlrev_b32 v228, 8, v228
    v_and_b32 v232, 1, v232
    v_lshl_or_b32 v232, v232, 2, v231
    v_lshlrev_b32 v232, 1, v232
    v_xor_b32 v232, v232, v230
    v_lshl_add_u32 v228, v232, 4, v228
    s_lshl_b32 s16, s6, 13
    s_add_u32 s16, s16, 32768
    v_add_u32 v228, s16, v228
    v_bfe_u32 v232, v1, 2, 2
    v_lshl_add_u32 v229, v230, 3, v232
    v_lshlrev_b32 v229, 8, v229
    v_and_b32 v230, 1, v230
    v_lshl_or_b32 v230, v230, 2, v232
    v_lshlrev_b32 v230, 1, v230
    s_lshl_b32 s16, s6, 2
    v_or_b32 v231, s16, v231
    v_xor_b32 v230, v230, v231
    v_lshl_add_u32 v229, v230, 4, v229
    v_add_u32 v229, 0, v229
    v_mov_b32 v241, s5
    v_mov_b32 v243, s5
    v_mov_b32 v245, s5
    v_mov_b32 v247, s5
    v_bfe_u32 v20, v0, 3, 2
    v_lshlrev_b32 v234, 11, v20
    v_lshrrev_b32 v22, 5, v0
    v_and_b32 v23, 7, v0
    v_lshlrev_b32 v22, 4, v22
    v_lshl_add_u32 v22, v23, 1, v22
    s_lshl_b32 s16, s15, 9
    s_add_u32 s16, s16, 131072
    v_lshl_add_u32 v234, v22, 2, v234
    v_add_u32 v234, s16, v234
    v_mul_u32_u24 v235, 320, v20
    v_lshl_add_u32 v235, v22, 1, v235
    v_add_u32 v235, 139264, v235
    v_lshrrev_b32 v236, 5, v0
    v_lshlrev_b32 v236, 9, v236
    v_and_b32 v23, 31, v0
    v_lshl_add_u32 v236, v23, 3, v236
    s_lshl_b32 s30, s15, 12
    s_add_u32 s30, s30, 65536
    s_add_u32 s31, s30, 16384
    v_and_b32 v237, 31, v1
    v_lshlrev_b32 v237, 3, v237
    v_add_u32 v237, s3, v237
    v_lshlrev_b32 v237, 6, v237
    v_add_u32 v237, 36864, v237
    s_waitcnt vmcnt(0) lgkmcnt(0)
    s_barrier
    s_cmp_lg_u32 s6, 3
    s_cbranch_scc1 L_cf_29
    s_lshl_b32 s16, s2, 7
    s_add_u32 s16, s16, 4096
    v_mov_b32 v40, s5
    s_mov_b32 exec_lo, 1
    s_mov_b32 exec_hi, 0
    buffer_store_dword v40, v3, s[8:11], s16 offen sc1
    s_mov_b64 exec, -1
L_cf_29:
    ds_read_b64_tr_b16 v[96:97], v229 offset:0
    ds_read_b64_tr_b16 v[98:99], v229 offset:1024
    ds_read_b64_tr_b16 v[100:101], v229 offset:8192
    ds_read_b64_tr_b16 v[102:103], v229 offset:9216
    ds_read_b64_tr_b16 v[104:105], v229 offset:16384
    ds_read_b64_tr_b16 v[106:107], v229 offset:17408
    ds_read_b64_tr_b16 v[108:109], v229 offset:24576
    ds_read_b64_tr_b16 v[110:111], v229 offset:25600
    ds_read_b64_tr_b16 v[112:113], v229 offset:8
    ds_read_b64_tr_b16 v[114:115], v229 offset:1032
    ds_read_b64_tr_b16 v[116:117], v229 offset:8200
    ds_read_b64_tr_b16 v[118:119], v229 offset:9224
    ds_read_b64_tr_b16 v[120:121], v229 offset:16392
    ds_read_b64_tr_b16 v[122:123], v229 offset:17416
    ds_read_b64_tr_b16 v[124:125], v229 offset:24584
    ds_read_b64_tr_b16 v[126:127], v229 offset:25608
    v_xor_b32 v20, 0, v228
    ds_read_b128 v[64:67], v20 offset:0
    ds_read_b128 v[80:83], v20 offset:1024
    v_xor_b32 v20, 64, v228
    ds_read_b128 v[68:71], v20 offset:0
    ds_read_b128 v[84:87], v20 offset:1024
    v_xor_b32 v20, 128, v228
    ds_read_b128 v[72:75], v20 offset:0
    ds_read_b128 v[88:91], v20 offset:1024
    v_xor_b32 v20, 192, v228
    ds_read_b128 v[76:79], v20 offset:0
    ds_read_b128 v[92:95], v20 offset:1024
    ds_read_b64 v[24:25], v234
    v_mov_b32 v20, v235
    s_mov_b32 s7, 0
L_poll_31:
    buffer_load_dwordx2 v[30:31], v236, s[8:11], s30 offen sc1
    buffer_load_dwordx2 v[32:33], v236, s[8:11], s30 offen offset:256 sc1
    buffer_load_dwordx2 v[34:35], v236, s[8:11], s31 offen sc1
    buffer_load_dwordx2 v[36:37], v236, s[8:11], s31 offen offset:256 sc1
    buffer_load_dwordx2 v[28:29], v237, s[8:11], 0 offen sc1
    s_waitcnt vmcnt(0)
    v_xor_b32 v38, s5, v31
    v_bitop3_b32 v38, v33, s5, v38 bitop3:0xbe
    v_bitop3_b32 v38, v35, s5, v38 bitop3:0xbe
    v_bitop3_b32 v38, v37, s5, v38 bitop3:0xbe
    v_bitop3_b32 v38, v28, s5, v38 bitop3:0xbe
    v_cmp_ne_u32 vcc, 0, v38
    s_cbranch_vccz L_pdone_32
    s_add_u32 s7, s7, 1
    s_cmp_lt_u32 s7, 400000
    s_cbranch_scc1 L_poll_31
L_pdone_32:
L_x1ok_30:
    s_waitcnt lgkmcnt(0)
    v_lshlrev_b32 v38, 16, v30
    v_and_b32 v39, 0xffff0000, v30
    v_lshlrev_b32 v42, 16, v32
    v_and_b32 v43, 0xffff0000, v32
    v_lshlrev_b32 v44, 16, v34
    v_and_b32 v45, 0xffff0000, v34
    v_lshlrev_b32 v46, 16, v36
    v_and_b32 v47, 0xffff0000, v36
    v_pk_add_f32 v[38:39], v[38:39], v[42:43]
    v_pk_add_f32 v[44:45], v[44:45], v[46:47]
    v_pk_add_f32 v[38:39], v[38:39], v[24:25]
    v_pk_fma_f32 v[38:39], v[24:25], v[44:45], v[38:39]
    v_cvt_pk_bf16_f32 v38, v38, v39
    ds_write_b32 v20, v38
    s_getreg_b32 s53, hwreg(HW_REG_XCC_ID, 0, 4)
    v_cmp_ne_u32 vcc, s53, v29
    s_cmp_eq_u64 vcc, 0
    s_cselect_b32 s52, 1, 0
    s_waitcnt lgkmcnt(0)
    s_barrier
    ds_read_b128 v[32:35], v224 offset:0
    ds_read_b128 v[36:39], v224 offset:64
    ds_read_b128 v[56:59], v224 offset:128
    ds_read_b128 v[60:63], v224 offset:192
    s_waitcnt lgkmcnt(3)
    v_mfma_f32_16x16x32_bf16 v[128:131], v[96:99], v[32:35], 0
    v_mfma_f32_16x16x32_bf16 v[132:135], v[112:115], v[32:35], 0
    s_waitcnt lgkmcnt(2)
    v_mfma_f32_16x16x32_bf16 v[128:131], v[100:103], v[36:39], v[128:131]
    v_mfma_f32_16x16x32_bf16 v[132:135], v[116:119], v[36:39], v[132:135]
    s_waitcnt lgkmcnt(1)
    v_mfma_f32_16x16x32_bf16 v[128:131], v[104:107], v[56:59], v[128:131]
    v_mfma_f32_16x16x32_bf16 v[132:135], v[120:123], v[56:59], v[132:135]
    s_waitcnt lgkmcnt(0)
    v_mfma_f32_16x16x32_bf16 v[128:131], v[108:111], v[60:63], v[128:131]
    v_mfma_f32_16x16x32_bf16 v[132:135], v[124:127], v[60:63], v[132:135]
    s_nop 6
    v_cvt_pk_bf16_f32 v240, v128, v129
    v_cvt_pk_bf16_f32 v242, v130, v131
    v_cvt_pk_bf16_f32 v244, v132, v133
    v_cvt_pk_bf16_f32 v246, v134, v135
    s_mov_b32 exec_lo, 0x000F000F
    s_mov_b32 exec_hi, 0x000F000F
    s_cmp_eq_u32 s52, 1
    s_cbranch_scc1 L_lp_33
    buffer_store_dwordx4 v[240:243], v225, s[8:11], s19 offen sc1
    buffer_store_dwordx4 v[244:247], v225, s[8:11], s19 offen offset:1024 sc1
    s_branch L_ld_34
L_lp_33:
    buffer_store_dwordx4 v[240:243], v225, s[8:11], s19 offen
    buffer_store_dwordx4 v[244:247], v225, s[8:11], s19 offen offset:1024
L_ld_34:
    s_mov_b64 exec, -1
    s_mov_b32 s7, 0
L_poll_35:
    buffer_load_dwordx4 v[96:99], v226, s[8:11], s20 offen offset:0 sc1
    buffer_load_dwordx4 v[100:103], v226, s[8:11], s20 offen offset:1024 sc1
    buffer_load_dwordx4 v[104:107], v226, s[8:11], s20 offen offset:2048 sc1
    buffer_load_dwordx4 v[108:111], v226, s[8:11], s20 offen offset:3072 sc1
    buffer_load_dwordx4 v[112:115], v226, s[8:11], s28 offen offset:0 sc1
    buffer_load_dwordx4 v[116:119], v226, s[8:11], s28 offen offset:1024 sc1
    buffer_load_dwordx4 v[120:123], v226, s[8:11], s28 offen offset:2048 sc1
    buffer_load_dwordx4 v[124:127], v226, s[8:11], s28 offen offset:3072 sc1
    s_waitcnt vmcnt(0)
    v_xor_b32 v22, s5, v97
    v_bitop3_b32 v22, v99, s5, v22 bitop3:0xbe
    v_bitop3_b32 v22, v101, s5, v22 bitop3:0xbe
    v_bitop3_b32 v22, v103, s5, v22 bitop3:0xbe
    v_bitop3_b32 v22, v105, s5, v22 bitop3:0xbe
    v_bitop3_b32 v22, v107, s5, v22 bitop3:0xbe
    v_bitop3_b32 v22, v109, s5, v22 bitop3:0xbe
    v_bitop3_b32 v22, v111, s5, v22 bitop3:0xbe
    v_bitop3_b32 v22, v113, s5, v22 bitop3:0xbe
    v_bitop3_b32 v22, v115, s5, v22 bitop3:0xbe
    v_bitop3_b32 v22, v117, s5, v22 bitop3:0xbe
    v_bitop3_b32 v22, v119, s5, v22 bitop3:0xbe
    v_bitop3_b32 v22, v121, s5, v22 bitop3:0xbe
    v_bitop3_b32 v22, v123, s5, v22 bitop3:0xbe
    v_bitop3_b32 v22, v125, s5, v22 bitop3:0xbe
    v_bitop3_b32 v22, v127, s5, v22 bitop3:0xbe
    v_cmp_ne_u32 vcc, 0, v22
    s_cbranch_vccz L_pdone_36
    s_add_u32 s7, s7, 1
    s_cmp_lt_u32 s7, 400000
    s_cbranch_scc1 L_poll_35
L_pdone_36:
    s_waitcnt lgkmcnt(0)
    v_mov_b32 v97, v98
    v_mov_b32 v98, v100
    v_mov_b32 v99, v102
    s_nop 1
    v_mfma_f32_16x16x32_bf16 v[128:131], v[64:67], v[96:99], 0
    v_mfma_f32_16x16x32_bf16 v[132:135], v[80:83], v[96:99], 0
    v_mov_b32 v105, v106
    v_mov_b32 v106, v108
    v_mov_b32 v107, v110
    s_nop 1
    v_mfma_f32_16x16x32_bf16 v[128:131], v[68:71], v[104:107], v[128:131]
    v_mfma_f32_16x16x32_bf16 v[132:135], v[84:87], v[104:107], v[132:135]
    v_mov_b32 v113, v114
    v_mov_b32 v114, v116
    v_mov_b32 v115, v118
    s_nop 1
    v_mfma_f32_16x16x32_bf16 v[128:131], v[72:75], v[112:115], v[128:131]
    v_mfma_f32_16x16x32_bf16 v[132:135], v[88:91], v[112:115], v[132:135]
    v_mov_b32 v121, v122
    v_mov_b32 v122, v124
    v_mov_b32 v123, v126
    s_nop 1
    v_mfma_f32_16x16x32_bf16 v[128:131], v[76:79], v[120:123], v[128:131]
    v_mfma_f32_16x16x32_bf16 v[132:135], v[92:95], v[120:123], v[132:135]
    s_nop 6
    v_add_f32_dpp v128, v128, v128 row_ror:8 row_mask:0xf bank_mask:0xf
    v_add_f32_dpp v129, v129, v129 row_ror:8 row_mask:0xf bank_mask:0xf
    v_add_f32_dpp v130, v130, v130 row_ror:8 row_mask:0xf bank_mask:0xf
    v_add_f32_dpp v131, v131, v131 row_ror:8 row_mask:0xf bank_mask:0xf
    v_add_f32_dpp v132, v132, v132 row_ror:8 row_mask:0xf bank_mask:0xf
    v_add_f32_dpp v133, v133, v133 row_ror:8 row_mask:0xf bank_mask:0xf
    v_add_f32_dpp v134, v134, v134 row_ror:8 row_mask:0xf bank_mask:0xf
    v_add_f32_dpp v135, v135, v135 row_ror:8 row_mask:0xf bank_mask:0xf
    v_add_f32_dpp v128, v128, v128 row_ror:4 row_mask:0xf bank_mask:0xf
    v_add_f32_dpp v129, v129, v129 row_ror:4 row_mask:0xf bank_mask:0xf
    v_add_f32_dpp v130, v130, v130 row_ror:4 row_mask:0xf bank_mask:0xf
    v_add_f32_dpp v131, v131, v131 row_ror:4 row_mask:0xf bank_mask:0xf
    v_add_f32_dpp v132, v132, v132 row_ror:4 row_mask:0xf bank_mask:0xf
    v_add_f32_dpp v133, v133, v133 row_ror:4 row_mask:0xf bank_mask:0xf
    v_add_f32_dpp v134, v134, v134 row_ror:4 row_mask:0xf bank_mask:0xf
    v_add_f32_dpp v135, v135, v135 row_ror:4 row_mask:0xf bank_mask:0xf
    v_cvt_pk_bf16_f32 v32, v128, v129
    v_cvt_pk_bf16_f32 v33, v130, v131
    v_cvt_pk_bf16_f32 v34, v132, v133
    v_cvt_pk_bf16_f32 v35, v134, v135
    s_mov_b32 exec_lo, 0x000F000F
    s_mov_b32 exec_hi, 0x000F000F
    buffer_store_dwordx4 v[32:35], v227, s[8:11], s21 offen sc1
    s_mov_b64 exec, -1
    v_and_b32 v21, 7, v1
    s_lshl_b32 s16, s6, 3
    v_add_u32 v21, s16, v21
    v_lshlrev_b32 v21, 3, v21
    s_lshl_b32 s16, s12, 1
    s_add_u32 s16, s16, 1
    v_add_u32 v21, s16, v21
    v_lshlrev_b32 v21, 7, v21
    s_mov_b32 s16, 4096
    s_mov_b32 s7, 0
L_poll_37:
    buffer_load_dword v22, v21, s[8:11], s16 offen sc1
    s_waitcnt vmcnt(0)
    v_cmp_ne_u32 vcc, s5, v22
    s_cbranch_vccz L_pdone_38
    s_sleep 2
    s_add_u32 s7, s7, 1
    s_cmp_lt_u32 s7, 400000
    s_cbranch_scc1 L_poll_37
L_pdone_38:
    s_lshl_b32 s16, s15, 7
    s_lshr_b32 s17, s6, 1
    s_lshl_b32 s17, s17, 6
    s_add_u32 s16, s16, s17
    s_and_b32 s17, s6, 1
    s_lshl_b32 s17, s17, 4
    s_add_u32 s16, s16, s17
    s_lshl_b32 s16, s16, 13
    s_lshl_b32 s17, s14, 8
    s_add_u32 s18, s16, s17
    v_lshrrev_b32 v20, 4, v1
    v_and_b32 v21, 15, v1
    v_lshlrev_b32 v22, 1, v20
    v_xor_b32 v23, v21, v22
    v_xor_b32 v24, 8, v23
    v_and_b32 v22, 1, v20
    v_lshlrev_b32 v22, 5, v22
    v_lshrrev_b32 v20, 1, v20
    v_add_u32 v20, v20, v22
    v_lshlrev_b32 v20, 13, v20
    v_lshl_add_u32 v23, v23, 4, v20
    v_lshl_add_u32 v24, v24, 4, v20
    s_lshl_b32 s17, s6, 13
    s_add_u32 m0, s17, 0
    s_mov_b32 s16, s18
    buffer_load_dwordx4 v23, s[64:67], s16 offen  lds
    s_add_u32 s16, s16, 16384
    s_add_u32 m0, m0, 1024
    s_nop 0
    buffer_load_dwordx4 v23, s[64:67], s16 offen  lds
    s_add_u32 s16, s16, 16384
    s_add_u32 m0, m0, 1024
    s_nop 0
    buffer_load_dwordx4 v24, s[64:67], s16 offen  lds
    s_add_u32 s16, s16, 16384
    s_add_u32 m0, m0, 1024
    s_nop 0
    buffer_load_dwordx4 v24, s[64:67], s16 offen  lds
    s_add_u32 s16, s16, 16384
    s_add_u32 m0, m0, 1024
    s_nop 0
    buffer_load_dwordx4 v23, s[64:67], s16 offen  lds
    s_add_u32 s16, s16, 16384
    s_add_u32 m0, m0, 1024
    s_nop 0
    buffer_load_dwordx4 v23, s[64:67], s16 offen  lds
    s_add_u32 s16, s16, 16384
    s_add_u32 m0, m0, 1024
    s_nop 0
    buffer_load_dwordx4 v24, s[64:67], s16 offen  lds
    s_add_u32 s16, s16, 16384
    s_add_u32 m0, m0, 1024
    s_nop 0
    buffer_load_dwordx4 v24, s[64:67], s16 offen  lds
    s_bitcmp1_b32 s4, 0
    s_cbranch_scc1 L_W_odd
    v_lshrrev_b32 v20, 3, v1
    v_lshlrev_b32 v20, 10, v20
    v_and_b32 v21, 7, v1
    v_lshl_add_u32 v20, v21, 4, v20
    s_lshl_b32 s16, s12, 3
    s_lshr_b32 s17, s4, 4
    s_lshl_b32 s17, s17, 2
    s_add_u32 s16, s16, s17
    s_add_u32 s16, s16, s6
    s_lshl_b32 s16, s16, 17
    s_bfe_u32 s17, s4, 0x30001
    s_lshl_b32 s17, s17, 7
    s_add_u32 s16, s16, s17
    s_lshl_b32 s17, s6, 14
    s_add_u32 m0, s17, 65536
    s_nop 0
    buffer_load_dwordx4 v20, s[68:71], s16 offen  lds
    s_add_u32 s16, s16, 8192
    s_add_u32 m0, m0, 1024
    s_nop 0
    buffer_load_dwordx4 v20, s[68:71], s16 offen  lds
    s_add_u32 s16, s16, 8192
    s_add_u32 m0, m0, 1024
    s_nop 0
    buffer_load_dwordx4 v20, s[68:71], s16 offen  lds
    s_add_u32 s16, s16, 8192
    s_add_u32 m0, m0, 1024
    s_nop 0
    buffer_load_dwordx4 v20, s[68:71], s16 offen  lds
    s_add_u32 s16, s16, 8192
    s_add_u32 m0, m0, 1024
    s_nop 0
    buffer_load_dwordx4 v20, s[68:71], s16 offen  lds
    s_add_u32 s16, s16, 8192
    s_add_u32 m0, m0, 1024
    s_nop 0
    buffer_load_dwordx4 v20, s[68:71], s16 offen  lds
    s_add_u32 s16, s16, 8192
    s_add_u32 m0, m0, 1024
    s_nop 0
    buffer_load_dwordx4 v20, s[68:71], s16 offen  lds
    s_add_u32 s16, s16, 8192
    s_add_u32 m0, m0, 1024
    s_nop 0
    buffer_load_dwordx4 v20, s[68:71], s16 offen  lds
    s_add_u32 s16, s16, 8192
    s_add_u32 m0, m0, 1024
    s_nop 0
    buffer_load_dwordx4 v20, s[68:71], s16 offen  lds
    s_add_u32 s16, s16, 8192
    s_add_u32 m0, m0, 1024
    s_nop 0
    buffer_load_dwordx4 v20, s[68:71], s16 offen  lds
    s_add_u32 s16, s16, 8192
    s_add_u32 m0, m0, 1024
    s_nop 0
    buffer_load_dwordx4 v20, s[68:71], s16 offen  lds
    s_add_u32 s16, s16, 8192
    s_add_u32 m0, m0, 1024
    s_nop 0
    buffer_load_dwordx4 v20, s[68:71], s16 offen  lds
    s_add_u32 s16, s16, 8192
    s_add_u32 m0, m0, 1024
    s_nop 0
    buffer_load_dwordx4 v20, s[68:71], s16 offen  lds
    s_add_u32 s16, s16, 8192
    s_add_u32 m0, m0, 1024
    s_nop 0
    buffer_load_dwordx4 v20, s[68:71], s16 offen  lds
    s_add_u32 s16, s16, 8192
    s_add_u32 m0, m0, 1024
    s_nop 0
    buffer_load_dwordx4 v20, s[68:71], s16 offen  lds
    s_add_u32 s16, s16, 8192
    s_add_u32 m0, m0, 1024
    s_nop 0
    buffer_load_dwordx4 v20, s[68:71], s16 offen  lds
    s_waitcnt vmcnt(16)
    s_barrier
    v_lshrrev_b32 v20, 4, v1
    v_bfe_u32 v21, v1, 2, 2
    v_lshl_add_u32 v128, v20, 3, v21
    v_lshlrev_b32 v128, 8, v128
    v_and_b32 v20, 1, v20
    v_lshl_or_b32 v20, v20, 2, v21
    v_lshlrev_b32 v20, 1, v20
    v_and_b32 v21, 3, v1
    s_lshl_b32 s16, s6, 2
    v_or_b32 v21, s16, v21
    v_xor_b32 v20, v20, v21
    v_lshl_add_u32 v20, v20, 4, v128
    v_add_u32 v20, 0, v20
    ds_read_b64_tr_b16 v[128:129], v20 offset:0
    ds_read_b64_tr_b16 v[130:131], v20 offset:1024
    ds_read_b64_tr_b16 v[132:133], v20 offset:8192
    ds_read_b64_tr_b16 v[134:135], v20 offset:9216
    ds_read_b64_tr_b16 v[136:137], v20 offset:16384
    ds_read_b64_tr_b16 v[138:139], v20 offset:17408
    ds_read_b64_tr_b16 v[140:141], v20 offset:24576
    ds_read_b64_tr_b16 v[142:143], v20 offset:25600
    ds_read_b64_tr_b16 v[144:145], v20 offset:8
    ds_read_b64_tr_b16 v[146:147], v20 offset:1032
    ds_read_b64_tr_b16 v[148:149], v20 offset:8200
    ds_read_b64_tr_b16 v[150:151], v20 offset:9224
    ds_read_b64_tr_b16 v[152:153], v20 offset:16392
    ds_read_b64_tr_b16 v[154:155], v20 offset:17416
    ds_read_b64_tr_b16 v[156:157], v20 offset:24584
    ds_read_b64_tr_b16 v[158:159], v20 offset:25608
    v_lshrrev_b32 v24, 4, v1
    v_bfe_u32 v25, v1, 2, 2
    v_lshl_add_u32 v24, v24, 3, v25
    v_and_b32 v25, 3, v1
    v_lshlrev_b32 v24, 7, v24
    v_lshl_add_u32 v24, v25, 4, v24
    s_lshl_b32 s16, s6, 14
    s_add_u32 s16, s16, 65536
    v_add_u32 v24, s16, v24
    s_waitcnt vmcnt(0)
    ds_read_b64_tr_b16 a[0:1], v24 offset:0
    ds_read_b64_tr_b16 a[2:3], v24 offset:512
    ds_read_b64_tr_b16 a[4:5], v24 offset:4096
    ds_read_b64_tr_b16 a[6:7], v24 offset:4608
    ds_read_b64_tr_b16 a[8:9], v24 offset:8192
    ds_read_b64_tr_b16 a[10:11], v24 offset:8704
    ds_read_b64_tr_b16 a[12:13], v24 offset:12288
    ds_read_b64_tr_b16 a[14:15], v24 offset:12800
    ds_read_b64_tr_b16 a[16:17], v24 offset:8
    ds_read_b64_tr_b16 a[18:19], v24 offset:520
    ds_read_b64_tr_b16 a[20:21], v24 offset:4104
    ds_read_b64_tr_b16 a[22:23], v24 offset:4616
    ds_read_b64_tr_b16 a[24:25], v24 offset:8200
    ds_read_b64_tr_b16 a[26:27], v24 offset:8712
    ds_read_b64_tr_b16 a[28:29], v24 offset:12296
    ds_read_b64_tr_b16 a[30:31], v24 offset:12808
    ds_read_b64_tr_b16 a[32:33], v24 offset:64
    ds_read_b64_tr_b16 a[34:35], v24 offset:576
    ds_read_b64_tr_b16 a[36:37], v24 offset:4160
    ds_read_b64_tr_b16 a[38:39], v24 offset:4672
    ds_read_b64_tr_b16 a[40:41], v24 offset:8256
    ds_read_b64_tr_b16 a[42:43], v24 offset:8768
    ds_read_b64_tr_b16 a[44:45], v24 offset:12352
    ds_read_b64_tr_b16 a[46:47], v24 offset:12864
    ds_read_b64_tr_b16 a[48:49], v24 offset:72
    ds_read_b64_tr_b16 a[50:51], v24 offset:584
    ds_read_b64_tr_b16 a[52:53], v24 offset:4168
    ds_read_b64_tr_b16 a[54:55], v24 offset:4680
    ds_read_b64_tr_b16 a[56:57], v24 offset:8264
    ds_read_b64_tr_b16 a[58:59], v24 offset:8776
    ds_read_b64_tr_b16 a[60:61], v24 offset:12360
    ds_read_b64_tr_b16 a[62:63], v24 offset:12872
    s_branch L_W_d
L_W_odd:
    s_lshl_b32 s13, s12, 4
    s_lshr_b32 s16, s4, 1
    s_add_u32 s13, s13, s16
    v_lshlrev_b32 v5, 4, v0
    buffer_load_dwordx4 v[8:11], v5, s[40:43], 0 offen
    v_lshrrev_b32 v6, 2, v1
    v_mul_u32_u24 v6, 6144, v6
    v_and_b32 v7, 3, v1
    v_lshl_add_u32 v6, v7, 4, v6
    s_lshl_b32 s16, s13, 6
    s_add_u32 s16, s16, 2048
    s_mul_i32 s17, s6, 786432
    s_add_u32 s16, s16, s17
    s_lshl_b32 s17, s6, 13
    s_add_u32 m0, s17, 65536
    s_nop 0
    buffer_load_dwordx4 v6, s[44:47], s16 offen  lds
    s_add_u32 s16, s16, 98304
    s_add_u32 m0, m0, 1024
    s_nop 0
    buffer_load_dwordx4 v6, s[44:47], s16 offen  lds
    s_add_u32 s16, s16, 98304
    s_add_u32 m0, m0, 1024
    s_nop 0
    buffer_load_dwordx4 v6, s[44:47], s16 offen  lds
    s_add_u32 s16, s16, 98304
    s_add_u32 m0, m0, 1024
    s_nop 0
    buffer_load_dwordx4 v6, s[44:47], s16 offen  lds
    s_add_u32 s16, s16, 98304
    s_add_u32 m0, m0, 1024
    s_nop 0
    buffer_load_dwordx4 v6, s[44:47], s16 offen  lds
    s_add_u32 s16, s16, 98304
    s_add_u32 m0, m0, 1024
    s_nop 0
    buffer_load_dwordx4 v6, s[44:47], s16 offen  lds
    s_add_u32 s16, s16, 98304
    s_add_u32 m0, m0, 1024
    s_nop 0
    buffer_load_dwordx4 v6, s[44:47], s16 offen  lds
    s_add_u32 s16, s16, 98304
    s_add_u32 m0, m0, 1024
    s_nop 0
    buffer_load_dwordx4 v6, s[44:47], s16 offen  lds
    s_waitcnt vmcnt(8)
    v_lshlrev_b32 v24, 16, v8
    v_and_b32 v25, 0xffff0000, v8
    v_lshlrev_b32 v26, 16, v9
    v_and_b32 v27, 0xffff0000, v9
    v_lshlrev_b32 v28, 16, v10
    v_and_b32 v29, 0xffff0000, v10
    v_lshlrev_b32 v30, 16, v11
    v_and_b32 v31, 0xffff0000, v11
    s_mov_b32 s16, 3216550459
    v_mul_f32 v32, s16, v24
    v_mul_f32 v33, s16, v25
    v_mul_f32 v34, s16, v26
    v_mul_f32 v35, s16, v27
    v_mul_f32 v36, s16, v28
    v_mul_f32 v37, s16, v29
    v_mul_f32 v38, s16, v30
    v_mul_f32 v39, s16, v31
    v_exp_f32 v32, v32
    v_exp_f32 v33, v33
    v_exp_f32 v34, v34
    v_exp_f32 v35, v35
    v_exp_f32 v36, v36
    v_exp_f32 v37, v37
    v_exp_f32 v38, v38
    v_exp_f32 v39, v39
    v_add_f32 v32, 1.0, v32
    v_add_f32 v33, 1.0, v33
    v_add_f32 v34, 1.0, v34
    v_add_f32 v35, 1.0, v35
    v_add_f32 v36, 1.0, v36
    v_add_f32 v37, 1.0, v37
    v_add_f32 v38, 1.0, v38
    v_add_f32 v39, 1.0, v39
    v_rcp_f32 v32, v32
    v_rcp_f32 v33, v33
    v_rcp_f32 v34, v34
    v_rcp_f32 v35, v35
    v_rcp_f32 v36, v36
    v_rcp_f32 v37, v37
    v_rcp_f32 v38, v38
    v_rcp_f32 v39, v39
    v_mul_f32 v24, v24, v32
    v_mul_f32 v25, v25, v33
    v_mul_f32 v26, v26, v34
    v_mul_f32 v27, v27, v35
    v_mul_f32 v28, v28, v36
    v_mul_f32 v29, v29, v37
    v_mul_f32 v30, v30, v38
    v_mul_f32 v31, v31, v39
    v_cvt_pk_bf16_f32 v8, v24, v25
    v_cvt_pk_bf16_f32 v9, v26, v27
    v_cvt_pk_bf16_f32 v10, v28, v29
    v_cvt_pk_bf16_f32 v11, v30, v31
    s_mul_i32 s16, s6, 1088
    s_add_u32 s16, s16, 98304
    v_lshl_add_u32 v20, v1, 4, s16
    ds_write_b128 v20, v[8:11]
    s_waitcnt lgkmcnt(0)
    s_barrier
    v_and_b32 v20, 3, v1
    v_mul_u32_u24 v20, 1088, v20
    v_lshrrev_b32 v21, 4, v1
    v_lshl_add_u32 v20, v21, 4, v20
    s_lshl_b32 s16, s6, 8
    s_add_u32 s16, s16, 98304
    v_add_u32 v20, s16, v20
    ds_read_b128 v[8:11], v20 offset:0
    ds_read_b128 v[12:15], v20 offset:64
    ds_read_b128 v[16:19], v20 offset:128
    ds_read_b128 v[20:23], v20 offset:192
    v_lshrrev_b32 v24, 4, v1
    v_bfe_u32 v25, v1, 2, 2
    v_lshl_add_u32 v24, v24, 3, v25
    v_and_b32 v25, 3, v1
    v_lshlrev_b32 v24, 6, v24
    v_lshl_add_u32 v24, v25, 3, v24
    s_lshl_b32 s16, s6, 13
    s_add_u32 s16, s16, 65536
    v_add_u32 v24, s16, v24
    s_waitcnt vmcnt(0)
    ds_read_b64_tr_b16 v[32:33], v24 offset:0
    ds_read_b64_tr_b16 v[34:35], v24 offset:256
    ds_read_b64_tr_b16 v[36:37], v24 offset:2048
    ds_read_b64_tr_b16 v[38:39], v24 offset:2304
    ds_read_b64_tr_b16 v[40:41], v24 offset:4096
    ds_read_b64_tr_b16 v[42:43], v24 offset:4352
    ds_read_b64_tr_b16 v[44:45], v24 offset:6144
    ds_read_b64_tr_b16 v[46:47], v24 offset:6400
    ds_read_b64_tr_b16 v[48:49], v24 offset:32
    ds_read_b64_tr_b16 v[50:51], v24 offset:288
    ds_read_b64_tr_b16 v[52:53], v24 offset:2080
    ds_read_b64_tr_b16 v[54:55], v24 offset:2336
    ds_read_b64_tr_b16 v[56:57], v24 offset:4128
    ds_read_b64_tr_b16 v[58:59], v24 offset:4384
    ds_read_b64_tr_b16 v[60:61], v24 offset:6176
    ds_read_b64_tr_b16 v[62:63], v24 offset:6432
    s_waitcnt lgkmcnt(0)
    v_mfma_f32_16x16x32_bf16 v[96:99], v[32:35], v[8:11], 0
    v_mfma_f32_16x16x32_bf16 v[96:99], v[36:39], v[12:15], v[96:99]
    v_mfma_f32_16x16x32_bf16 v[96:99], v[40:43], v[16:19], v[96:99]
    v_mfma_f32_16x16x32_bf16 v[96:99], v[44:47], v[20:23], v[96:99]
    v_mfma_f32_16x16x32_bf16 v[100:103], v[48:51], v[8:11], 0
    v_mfma_f32_16x16x32_bf16 v[100:103], v[52:55], v[12:15], v[100:103]
    v_mfma_f32_16x16x32_bf16 v[100:103], v[56:59], v[16:19], v[100:103]
    v_mfma_f32_16x16x32_bf16 v[100:103], v[60:63], v[20:23], v[100:103]
    s_lshl_b32 s16, s6, 10
    s_add_u32 s16, s16, 143360
    v_lshl_add_u32 v20, v1, 4, s16
    s_nop 0
    ds_write_b128 v20, v[96:99] offset:0
    s_nop 2
    ds_write_b128 v20, v[100:103] offset:4096
    s_waitcnt lgkmcnt(0)
    s_barrier
    s_cmp_ge_u32 s6, 2
    s_cbranch_scc1 L_mskip_39
    s_lshl_b32 s16, s6, 12
    s_add_u32 s16, s16, 143360
    v_lshl_add_u32 v20, v1, 4, s16
    ds_read_b128 v[32:35], v20 offset:0
    ds_read_b128 v[36:39], v20 offset:1024
    ds_read_b128 v[40:43], v20 offset:2048
    ds_read_b128 v[44:47], v20 offset:3072
    v_and_b32 v21, 3, v1
    v_lshrrev_b32 v22, 4, v1
    v_lshlrev_b32 v21, 6, v21
    v_lshl_add_u32 v21, v22, 4, v21
    s_lshl_b32 s16, s13, 1
    s_add_u32 s16, s16, s6
    s_lshl_b32 s16, s16, 8
    s_add_u32 s16, s16, 98304
    s_waitcnt lgkmcnt(0)
    v_pk_add_f32 v[32:33], v[32:33], v[36:37]
    v_pk_add_f32 v[34:35], v[34:35], v[38:39]
    v_pk_add_f32 v[40:41], v[40:41], v[44:45]
    v_pk_add_f32 v[42:43], v[42:43], v[46:47]
    v_pk_add_f32 v[32:33], v[32:33], v[40:41]
    v_pk_add_f32 v[34:35], v[34:35], v[42:43]
    v_cvt_pk_bf16_f32 v36, v32, v33
    v_cvt_pk_bf16_f32 v38, v34, v35
    v_mov_b32 v37, s5
    v_mov_b32 v39, s5
    s_mov_b32 exec_lo, 0x000F000F
    s_mov_b32 exec_hi, 0x000F000F
    buffer_store_dwordx4 v[36:39], v21, s[8:11], s16 offen sc1
    s_mov_b64 exec, -1
L_mskip_39:
    v_lshrrev_b32 v20, 4, v1
    v_bfe_u32 v21, v1, 2, 2
    v_lshl_add_u32 v128, v20, 3, v21
    v_lshlrev_b32 v128, 8, v128
    v_and_b32 v20, 1, v20
    v_lshl_or_b32 v20, v20, 2, v21
    v_lshlrev_b32 v20, 1, v20
    v_and_b32 v21, 3, v1
    s_lshl_b32 s16, s6, 2
    v_or_b32 v21, s16, v21
    v_xor_b32 v20, v20, v21
    v_lshl_add_u32 v20, v20, 4, v128
    v_add_u32 v20, 0, v20
    ds_read_b64_tr_b16 v[128:129], v20 offset:0
    ds_read_b64_tr_b16 v[130:131], v20 offset:1024
    ds_read_b64_tr_b16 v[132:133], v20 offset:8192
    ds_read_b64_tr_b16 v[134:135], v20 offset:9216
    ds_read_b64_tr_b16 v[136:137], v20 offset:16384
    ds_read_b64_tr_b16 v[138:139], v20 offset:17408
    ds_read_b64_tr_b16 v[140:141], v20 offset:24576
    ds_read_b64_tr_b16 v[142:143], v20 offset:25600
    ds_read_b64_tr_b16 v[144:145], v20 offset:8
    ds_read_b64_tr_b16 v[146:147], v20 offset:1032
    ds_read_b64_tr_b16 v[148:149], v20 offset:8200
    ds_read_b64_tr_b16 v[150:151], v20 offset:9224
    ds_read_b64_tr_b16 v[152:153], v20 offset:16392
    ds_read_b64_tr_b16 v[154:155], v20 offset:17416
    ds_read_b64_tr_b16 v[156:157], v20 offset:24584
    ds_read_b64_tr_b16 v[158:159], v20 offset:25608
L_W_d:
    v_and_b32 v20, 31, v1
    v_lshlrev_b32 v42, 7, v20
    v_lshlrev_b32 v20, 9, v20
    s_lshl_b32 s17, s6, 14
    s_lshl_b32 s16, s14, 4
    s_add_u32 s17, s17, s16
    s_add_u32 s17, s17, 524288
    s_lshl_b32 s22, s15, 2
    s_add_u32 s22, s22, s6
    s_lshl_b32 s22, s22, 12
    s_add_u32 s22, s22, 983040
    v_lshrrev_b32 v30, 4, v1
    v_lshlrev_b32 v21, 11, v30
    v_and_b32 v22, 15, v1
    v_lshl_add_u32 v21, v22, 4, v21
    s_lshl_b32 s18, s14, 2
    s_add_u32 s18, s18, s15
    s_mul_i32 s18, s18, 37120
    s_lshl_b32 s16, s6, 13
    s_add_u32 s18, s18, s16
    s_add_u32 s18, s18, 1048576
    s_lshl_b32 s16, s6, 6
    s_add_u32 s16, s16, 142336
    v_and_b32 v26, 31, v1
    v_lshl_add_u32 v26, v26, 1, s16
    v_lshl_add_u32 v27, v30, 4, s16
    s_mul_i32 s16, s6, 320
    s_add_u32 s16, s16, 140800
    v_lshl_add_u32 v28, v22, 4, s16
    v_and_b32 v29, 3, v1
    v_mul_u32_u24 v29, 320, v29
    v_lshl_add_u32 v29, v30, 4, v29
    v_add_u32 v29, 140800, v29
    v_and_b32 v31, 3, v1
    v_lshlrev_b32 v31, 6, v31
    v_lshl_add_u32 v31, v30, 4, v31
    s_lshl_b32 s19, s14, 12
    s_lshl_b32 s16, s6, 10
    s_add_u32 s19, s19, s16
    s_lshl_b32 s16, s15, 8
    s_add_u32 s19, s19, s16
    s_add_u32 s19, s19, 589824
    v_lshlrev_b32 v44, 6, v22
    v_lshl_add_u32 v44, v30, 4, v44
    s_lshl_b32 s23, s12, 3
    s_lshr_b32 s16, s4, 4
    s_lshl_b32 s16, s16, 2
    s_add_u32 s23, s23, s16
    s_add_u32 s23, s23, s6
    s_lshl_b32 s23, s23, 12
    s_add_u32 s23, s23, 589824
    s_lshl_b32 s16, s6, 12
    s_add_u32 s16, s16, 143360
    v_lshl_add_u32 v45, v1, 4, s16
    s_lshl_b32 s16, s6, 11
    s_add_u32 s16, s16, 143360
    v_lshl_add_u32 v46, v1, 4, s16
    v_and_b32 v47, 3, v1
    v_lshlrev_b32 v47, 10, v47
    v_lshl_add_u32 v47, v30, 4, v47
    s_lshl_b32 s25, s12, 1
    s_lshr_b32 s16, s4, 4
    s_add_u32 s25, s25, s16
    s_lshl_b32 s25, s25, 12
    s_bfe_u32 s16, s4, 0x30001
    s_lshl_b32 s16, s16, 7
    s_add_u32 s25, s25, s16
    s_lshl_b32 s16, s6, 6
    s_add_u32 s25, s25, s16
    s_add_u32 s25, s25, 720896
    s_mov_b32 s26, 0x05040100
    s_mov_b32 s27, 0x07060302
    v_and_b32 v48, 3, v1
    s_lshr_b32 s16, s4, 4
    s_lshl_b32 s16, s16, 2
    s_add_u32 s16, s16, s6
    s_lshl_b32 s16, s16, 2
    v_add_u32 v48, s16, v48
    v_lshlrev_b32 v48, 3, v48
    s_lshl_b32 s16, s12, 1
    s_add_u32 s16, s16, 1
    v_add_u32 v48, s16, v48
    v_lshlrev_b32 v48, 7, v48
    v_add_u32 v48, 4096, v48
    s_mov_b32 s7, 0
L_poll_40:
    buffer_load_dwordx4 v[32:35], v20, s[8:11], s17 offen sc1
    s_waitcnt vmcnt(0)
    v_xor_b32 v36, s5, v34
    v_bitop3_b32 v36, v35, s5, v36 bitop3:0xbe
    v_cmp_ne_u32 vcc, 0, v36
    s_cbranch_vccz L_pdone_41
    s_sleep 2
    s_add_u32 s7, s7, 1
    s_cmp_lt_u32 s7, 400000
    s_cbranch_scc1 L_poll_40
L_pdone_41:
    v_mov_b32 v34, v32
    s_nop 1
    v_max_f32_dpp v34, v34, v34 row_ror:8 row_mask:0xf bank_mask:0xf
    s_nop 1
    v_max_f32_dpp v34, v34, v34 row_ror:4 row_mask:0xf bank_mask:0xf
    s_nop 1
    v_max_f32_dpp v34, v34, v34 row_ror:2 row_mask:0xf bank_mask:0xf
    s_nop 1
    v_max_f32_dpp v34, v34, v34 row_ror:1 row_mask:0xf bank_mask:0xf
    v_mov_b32 v35, v34
    s_nop 1
    v_permlane16_swap_b32 v34, v35
    v_max_f32 v34, v34, v35
    v_sub_f32 v34, v32, v34
    v_mul_f32 v34, 1040356334, v34
    v_exp_f32 v34, v34
    s_nop 0
    v_mul_f32 v35, v34, v33
    s_nop 1
    v_add_f32_dpp v35, v35, v35 row_ror:8 row_mask:0xf bank_mask:0xf
    s_nop 1
    v_add_f32_dpp v35, v35, v35 row_ror:4 row_mask:0xf bank_mask:0xf
    s_nop 1
    v_add_f32_dpp v35, v35, v35 row_ror:2 row_mask:0xf bank_mask:0xf
    s_nop 1
    v_add_f32_dpp v35, v35, v35 row_ror:1 row_mask:0xf bank_mask:0xf
    v_mov_b32 v36, v35
    s_nop 1
    v_permlane16_swap_b32 v35, v36
    v_add_f32 v35, v35, v36
    v_rcp_f32 v35, v35
    s_nop 0
    v_mul_f32 v34, v34, v35
    v_cvt_pk_bf16_f32 v34, v34, v34
    ds_write_b16 v26, v34
    s_waitcnt lgkmcnt(0)
    ds_read_b128 v[36:39], v27
    v_and_b32 v42, 31, v1
    v_lshlrev_b32 v42, 8, v42
    v_add_u32 v42, 128, v42
    s_mov_b32 s7, 0
L_poll_42:
    buffer_load_dword v43, v42, s[8:11], s18 offen sc1
    s_waitcnt vmcnt(0)
    v_cmp_eq_u32 vcc, -1, v43
    s_cbranch_vccz L_pdone_43
    s_sleep 1
    s_add_u32 s7, s7, 1
    s_cmp_lt_u32 s7, 400000
    s_cbranch_scc1 L_poll_42
L_pdone_43:
    s_mov_b32 s7, 0
L_poll_44:
    buffer_load_dwordx4 v[64:67], v21, s[8:11], s18 offen offset:0 sc1
    buffer_load_dwordx4 v[68:71], v21, s[8:11], s18 offen offset:256 sc1
    buffer_load_dwordx4 v[72:75], v21, s[8:11], s18 offen offset:512 sc1
    buffer_load_dwordx4 v[76:79], v21, s[8:11], s18 offen offset:768 sc1
    buffer_load_dwordx4 v[80:83], v21, s[8:11], s18 offen offset:1024 sc1
    buffer_load_dwordx4 v[84:87], v21, s[8:11], s18 offen offset:1280 sc1
    buffer_load_dwordx4 v[88:91], v21, s[8:11], s18 offen offset:1536 sc1
    buffer_load_dwordx4 v[92:95], v21, s[8:11], s18 offen offset:1792 sc1
    s_waitcnt vmcnt(0)
    v_max3_u32 v43, v64, v65, v66
    v_max3_u32 v43, v43, v67, v68
    v_max3_u32 v43, v43, v69, v70
    v_max3_u32 v43, v43, v71, v72
    v_max3_u32 v43, v43, v73, v74
    v_max3_u32 v43, v43, v75, v76
    v_max3_u32 v43, v43, v77, v78
    v_max3_u32 v43, v43, v79, v80
    v_max3_u32 v43, v43, v81, v82
    v_max3_u32 v43, v43, v83, v84
    v_max3_u32 v43, v43, v85, v86
    v_max3_u32 v43, v43, v87, v88
    v_max3_u32 v43, v43, v89, v90
    v_max3_u32 v43, v43, v91, v92
    v_max3_u32 v43, v43, v93, v94
    v_max_u32 v43, v43, v95
    v_cmp_eq_u32 vcc, -1, v43
    s_cbranch_vccz L_pdone_45
    s_add_u32 s7, s7, 1
    s_cmp_lt_u32 s7, 400000
    s_cbranch_scc1 L_poll_44
L_pdone_45:
    s_waitcnt lgkmcnt(0)
    v_perm_b32 v96, v68, v64, s26
    v_perm_b32 v97, v76, v72, s26
    v_perm_b32 v98, v84, v80, s26
    v_perm_b32 v99, v92, v88, s26
    s_nop 1
    v_mfma_f32_16x16x32_bf16 v[192:195], v[36:39], v[96:99], 0
    v_perm_b32 v100, v68, v64, s27
    v_perm_b32 v101, v76, v72, s27
    v_perm_b32 v102, v84, v80, s27
    v_perm_b32 v103, v92, v88, s27
    s_nop 1
    v_mfma_f32_16x16x32_bf16 v[196:199], v[36:39], v[100:103], 0
    v_perm_b32 v104, v69, v65, s26
    v_perm_b32 v105, v77, v73, s26
    v_perm_b32 v106, v85, v81, s26
    v_perm_b32 v107, v93, v89, s26
    s_nop 1
    v_mfma_f32_16x16x32_bf16 v[200:203], v[36:39], v[104:107], 0
    v_perm_b32 v108, v69, v65, s27
    v_perm_b32 v109, v77, v73, s27
    v_perm_b32 v110, v85, v81, s27
    v_perm_b32 v111, v93, v89, s27
    s_nop 1
    v_mfma_f32_16x16x32_bf16 v[204:207], v[36:39], v[108:111], 0
    v_perm_b32 v112, v70, v66, s26
    v_perm_b32 v113, v78, v74, s26
    v_perm_b32 v114, v86, v82, s26
    v_perm_b32 v115, v94, v90, s26
    s_nop 1
    v_mfma_f32_16x16x32_bf16 v[208:211], v[36:39], v[112:115], 0
    v_perm_b32 v116, v70, v66, s27
    v_perm_b32 v117, v78, v74, s27
    v_perm_b32 v118, v86, v82, s27
    v_perm_b32 v119, v94, v90, s27
    s_nop 1
    v_mfma_f32_16x16x32_bf16 v[212:215], v[36:39], v[116:119], 0
    v_perm_b32 v120, v71, v67, s26
    v_perm_b32 v121, v79, v75, s26
    v_perm_b32 v122, v87, v83, s26
    v_perm_b32 v123, v95, v91, s26
    s_nop 1
    v_mfma_f32_16x16x32_bf16 v[216:219], v[36:39], v[120:123], 0
    v_perm_b32 v124, v71, v67, s27
    v_perm_b32 v125, v79, v75, s27
    v_perm_b32 v126, v87, v83, s27
    v_perm_b32 v127, v95, v91, s27
    s_nop 1
    v_mfma_f32_16x16x32_bf16 v[220:223], v[36:39], v[124:127], 0
    v_cvt_pk_bf16_f32 v40, v192, v196
    v_cvt_pk_bf16_f32 v41, v200, v204
    v_cvt_pk_bf16_f32 v42, v208, v212
    s_nop 4
    v_cvt_pk_bf16_f32 v43, v216, v220
    ds_write_b128 v28, v[40:43]
    s_waitcnt lgkmcnt(0)
    s_barrier
    ds_read_b128 v[48:51], v29 offset:0
    ds_read_b128 v[52:55], v29 offset:64
    ds_read_b128 v[56:59], v29 offset:128
    ds_read_b128 v[60:63], v29 offset:192
    s_waitcnt lgkmcnt(3)
    v_mfma_f32_16x16x32_bf16 v[192:195], v[128:131], v[48:51], 0
    v_mfma_f32_16x16x32_bf16 v[196:199], v[144:147], v[48:51], 0
    s_waitcnt lgkmcnt(2)
    v_mfma_f32_16x16x32_bf16 v[192:195], v[132:135], v[52:55], v[192:195]
    v_mfma_f32_16x16x32_bf16 v[196:199], v[148:151], v[52:55], v[196:199]
    s_waitcnt lgkmcnt(1)
    v_mfma_f32_16x16x32_bf16 v[192:195], v[136:139], v[56:59], v[192:195]
    v_mfma_f32_16x16x32_bf16 v[196:199], v[152:155], v[56:59], v[196:199]
    s_waitcnt lgkmcnt(0)
    v_mfma_f32_16x16x32_bf16 v[192:195], v[140:143], v[60:63], v[192:195]
    v_mfma_f32_16x16x32_bf16 v[196:199], v[156:159], v[60:63], v[196:199]
    s_nop 6
    v_cvt_pk_bf16_f32 v32, v192, v193
    v_cvt_pk_bf16_f32 v33, v194, v195
    v_cvt_pk_bf16_f32 v34, v196, v197
    v_cvt_pk_bf16_f32 v35, v198, v199
    s_mov_b32 exec_lo, 0x000F000F
    s_mov_b32 exec_hi, 0x000F000F
    s_cmp_eq_u32 s52, 1
    s_cbranch_scc1 L_lp_46
    buffer_store_dwordx4 v[32:35], v31, s[8:11], s19 offen sc1
    s_branch L_ld_47
L_lp_46:
    buffer_store_dwordx4 v[32:35], v31, s[8:11], s19 offen
L_ld_47:
    s_mov_b64 exec, -1
    s_bitcmp1_b32 s4, 0
    s_cbranch_scc1 L_W_end
    s_mov_b32 s7, 0
L_poll_48:
    buffer_load_dwordx4 v[64:67], v44, s[8:11], s23 offen offset:0 sc1
    buffer_load_dwordx4 v[68:71], v44, s[8:11], s23 offen offset:1024 sc1
    buffer_load_dwordx4 v[72:75], v44, s[8:11], s23 offen offset:2048 sc1
    buffer_load_dwordx4 v[76:79], v44, s[8:11], s23 offen offset:3072 sc1
    s_waitcnt vmcnt(0)
    v_max3_u32 v24, v64, v65, v66
    v_max3_u32 v24, v24, v67, v68
    v_max3_u32 v24, v24, v69, v70
    v_max3_u32 v24, v24, v71, v72
    v_max3_u32 v24, v24, v73, v74
    v_max3_u32 v24, v24, v75, v76
    v_max3_u32 v24, v24, v77, v78
    v_max_u32 v24, v24, v79
    v_cmp_eq_u32 vcc, -1, v24
    s_cbranch_vccz L_pdone_49
    s_add_u32 s7, s7, 1
    s_cmp_lt_u32 s7, 400000
    s_cbranch_scc1 L_poll_48
L_pdone_49:
    v_mfma_f32_16x16x32_bf16 v[80:83], a[0:3], v[64:67], 0
    v_mfma_f32_16x16x32_bf16 v[84:87], a[16:19], v[64:67], 0
    v_mfma_f32_16x16x32_bf16 v[88:91], a[32:35], v[64:67], 0
    v_mfma_f32_16x16x32_bf16 v[92:95], a[48:51], v[64:67], 0
    v_mfma_f32_16x16x32_bf16 v[80:83], a[4:7], v[68:71], v[80:83]
    v_mfma_f32_16x16x32_bf16 v[84:87], a[20:23], v[68:71], v[84:87]
    v_mfma_f32_16x16x32_bf16 v[88:91], a[36:39], v[68:71], v[88:91]
    v_mfma_f32_16x16x32_bf16 v[92:95], a[52:55], v[68:71], v[92:95]
    v_mfma_f32_16x16x32_bf16 v[80:83], a[8:11], v[72:75], v[80:83]
    v_mfma_f32_16x16x32_bf16 v[84:87], a[24:27], v[72:75], v[84:87]
    v_mfma_f32_16x16x32_bf16 v[88:91], a[40:43], v[72:75], v[88:91]
    v_mfma_f32_16x16x32_bf16 v[92:95], a[56:59], v[72:75], v[92:95]
    v_mfma_f32_16x16x32_bf16 v[80:83], a[12:15], v[76:79], v[80:83]
    v_mfma_f32_16x16x32_bf16 v[84:87], a[28:31], v[76:79], v[84:87]
    v_mfma_f32_16x16x32_bf16 v[88:91], a[44:47], v[76:79], v[88:91]
    v_mfma_f32_16x16x32_bf16 v[92:95], a[60:63], v[76:79], v[92:95]
    s_nop 4
    v_add_f32_dpp v80, v80, v80 row_ror:8 row_mask:0xf bank_mask:0xf
    v_add_f32_dpp v81, v81, v81 row_ror:8 row_mask:0xf bank_mask:0xf
    v_add_f32_dpp v82, v82, v82 row_ror:8 row_mask:0xf bank_mask:0xf
    v_add_f32_dpp v83, v83, v83 row_ror:8 row_mask:0xf bank_mask:0xf
    v_add_f32_dpp v84, v84, v84 row_ror:8 row_mask:0xf bank_mask:0xf
    v_add_f32_dpp v85, v85, v85 row_ror:8 row_mask:0xf bank_mask:0xf
    v_add_f32_dpp v86, v86, v86 row_ror:8 row_mask:0xf bank_mask:0xf
    v_add_f32_dpp v87, v87, v87 row_ror:8 row_mask:0xf bank_mask:0xf
    v_add_f32_dpp v88, v88, v88 row_ror:8 row_mask:0xf bank_mask:0xf
    v_add_f32_dpp v89, v89, v89 row_ror:8 row_mask:0xf bank_mask:0xf
    v_add_f32_dpp v90, v90, v90 row_ror:8 row_mask:0xf bank_mask:0xf
    v_add_f32_dpp v91, v91, v91 row_ror:8 row_mask:0xf bank_mask:0xf
    v_add_f32_dpp v92, v92, v92 row_ror:8 row_mask:0xf bank_mask:0xf
    v_add_f32_dpp v93, v93, v93 row_ror:8 row_mask:0xf bank_mask:0xf
    v_add_f32_dpp v94, v94, v94 row_ror:8 row_mask:0xf bank_mask:0xf
    v_add_f32_dpp v95, v95, v95 row_ror:8 row_mask:0xf bank_mask:0xf
    v_add_f32_dpp v80, v80, v80 row_ror:4 row_mask:0xf bank_mask:0xf
    v_add_f32_dpp v81, v81, v81 row_ror:4 row_mask:0xf bank_mask:0xf
    v_add_f32_dpp v82, v82, v82 row_ror:4 row_mask:0xf bank_mask:0xf
    v_add_f32_dpp v83, v83, v83 row_ror:4 row_mask:0xf bank_mask:0xf
    v_add_f32_dpp v84, v84, v84 row_ror:4 row_mask:0xf bank_mask:0xf
    v_add_f32_dpp v85, v85, v85 row_ror:4 row_mask:0xf bank_mask:0xf
    v_add_f32_dpp v86, v86, v86 row_ror:4 row_mask:0xf bank_mask:0xf
    v_add_f32_dpp v87, v87, v87 row_ror:4 row_mask:0xf bank_mask:0xf
    v_add_f32_dpp v88, v88, v88 row_ror:4 row_mask:0xf bank_mask:0xf
    v_add_f32_dpp v89, v89, v89 row_ror:4 row_mask:0xf bank_mask:0xf
    v_add_f32_dpp v90, v90, v90 row_ror:4 row_mask:0xf bank_mask:0xf
    v_add_f32_dpp v91, v91, v91 row_ror:4 row_mask:0xf bank_mask:0xf
    v_add_f32_dpp v92, v92, v92 row_ror:4 row_mask:0xf bank_mask:0xf
    v_add_f32_dpp v93, v93, v93 row_ror:4 row_mask:0xf bank_mask:0xf
    v_add_f32_dpp v94, v94, v94 row_ror:4 row_mask:0xf bank_mask:0xf
    v_add_f32_dpp v95, v95, v95 row_ror:4 row_mask:0xf bank_mask:0xf
    ds_write_b128 v45, v[80:83] offset:0
    ds_write_b128 v45, v[84:87] offset:1024
    ds_write_b128 v45, v[88:91] offset:2048
    ds_write_b128 v45, v[92:95] offset:3072
    s_waitcnt lgkmcnt(0)
    s_barrier
    s_cmp_ge_u32 s6, 2
    s_cbranch_scc1 L_eskip_50
    ds_read_b128 v[64:67], v46 offset:0
    ds_read_b128 v[68:71], v46 offset:4096
    ds_read_b128 v[72:75], v46 offset:8192
    ds_read_b128 v[76:79], v46 offset:12288
    ds_read_b128 v[80:83], v46 offset:1024
    ds_read_b128 v[84:87], v46 offset:5120
    ds_read_b128 v[88:91], v46 offset:9216
    ds_read_b128 v[92:95], v46 offset:13312
    s_waitcnt lgkmcnt(4)
    v_pk_add_f32 v[64:65], v[64:65], v[68:69]
    v_pk_add_f32 v[66:67], v[66:67], v[70:71]
    v_pk_add_f32 v[72:73], v[72:73], v[76:77]
    v_pk_add_f32 v[74:75], v[74:75], v[78:79]
    v_pk_add_f32 v[64:65], v[64:65], v[72:73]
    v_pk_add_f32 v[66:67], v[66:67], v[74:75]
    v_cvt_pk_bf16_f32 v36, v64, v65
    v_cvt_pk_bf16_f32 v37, v66, v67
    s_waitcnt lgkmcnt(0)
    v_pk_add_f32 v[80:81], v[80:81], v[84:85]
    v_pk_add_f32 v[82:83], v[82:83], v[86:87]
    v_pk_add_f32 v[88:89], v[88:89], v[92:93]
    v_pk_add_f32 v[90:91], v[90:91], v[94:95]
    v_pk_add_f32 v[80:81], v[80:81], v[88:89]
    v_pk_add_f32 v[82:83], v[82:83], v[90:91]
    v_cvt_pk_bf16_f32 v38, v80, v81
    v_cvt_pk_bf16_f32 v39, v82, v83
    s_mov_b32 exec_lo, 0x000F000F
    s_mov_b32 exec_hi, 0x000F000F
    buffer_store_dwordx4 v[36:39], v47, s[8:11], s25 offen sc1
    s_mov_b64 exec, -1
L_eskip_50:
L_W_end:
    s_endpgm
L_code_end:
    s_endpgm
.section .rodata,"a"
.p2align 6
.amdhsa_kernel adaLN_cond__compressed_kv_cla__dense_activation_relu__decode_kernel
  .amdhsa_next_free_vgpr 512
  .amdhsa_next_free_sgpr 102
  .amdhsa_accum_offset 256
  .amdhsa_group_segment_fixed_size 0
  .amdhsa_kernarg_size 112
  .amdhsa_user_sgpr_count 2
  .amdhsa_user_sgpr_kernarg_segment_ptr 1
  .amdhsa_system_sgpr_workgroup_id_x 1
.end_amdhsa_kernel
```
